```python
import torch

def _softmax(x, axis=-1):
    return torch.softmax(x, dim=axis)
def _gelu(x):
    return torch.nn.functional.gelu(x, approximate="tanh")
def _silu(x):
    return torch.nn.functional.silu(x)
def _sigmoid(x):
    return torch.sigmoid(x)
def _layernorm(x, axis=-1, eps=1e-5):
    m = x.mean(dim=axis, keepdim=True)
    v = x.var(dim=axis, keepdim=True, unbiased=False)
    return (x - m) / torch.sqrt(v + eps)
def _scatter_add(tgt, idx, src, axis=0):
    return tgt.clone().index_add_(axis, idx, src)
def _segment_sum(src, seg, n):
    out = torch.zeros((n,) + src.shape[1:], dtype=src.dtype)
    return out.index_add_(0, seg, src)
def _pad(x, pw):
    flat = tuple(v for pair in reversed(pw) for v in pair)
    return torch.nn.functional.pad(x, flat)

kernel_name = 'gated_mix__ssm_conv_s4__dense_activation_mish__prompt'

def setup_inputs():

    _w = (lambda a: (lambda t: t.to(torch.bfloat16) if t.is_floating_point() else t)(torch.as_tensor(a)))
    def _A_setup():
        B, L, D, N = 1, 2048, 576, 128
        A_re = -(lambda _x: torch.exp(torch.as_tensor(_x)))((lambda *s: torch.randn(*s, dtype=torch.bfloat16) * 6.4)(D, N))
        A_im = torch.pi * (lambda *s: torch.randn(*s, dtype=torch.bfloat16) * 0.05)(D, N)
        B_re = (lambda *s: torch.randn(*s, dtype=torch.bfloat16) * 0.1)(D, N)
        B_im = (lambda *s: torch.randn(*s, dtype=torch.bfloat16) * 0.1)(D, N)
        C_re = (lambda *s: torch.randn(*s, dtype=torch.bfloat16) * 0.1)(D, N)
        C_im = (lambda *s: torch.randn(*s, dtype=torch.bfloat16) * 0.1)(D, N)
        log_dt = (lambda *s: torch.randn(*s, dtype=torch.bfloat16) * 0.05)(D) * 0.5 - 4.0
        Dskip = (lambda *s: torch.randn(*s, dtype=torch.bfloat16) * 0.05)(D)
        return {
            "u": _w((lambda *s: torch.randn(*s, dtype=torch.bfloat16) * 0.05)(B, L, D)),
            "A_re": _w(A_re),
            "A_im": _w(A_im),
            "B_re": _w(B_re),
            "B_im": _w(B_im),
            "C_re": _w(C_re),
            "C_im": _w(C_im),
            "log_dt": _w(log_dt),
            "Dskip": _w(Dskip),
        }
    _A_in = _A_setup()

    def _B_setup():
        B, S, D, F = 1, 2048, 576, 4608
        return {
            "x": _w((lambda *s: torch.randn(*s, dtype=torch.bfloat16) * 0.05)(B, S, D)),
            "w1": _w((lambda *s: torch.randn(*s, dtype=torch.bfloat16) * 6.4)(D, F) * (D ** -0.5)),
            "b1": _w((lambda *s: torch.randn(*s, dtype=torch.bfloat16) * 0.05)(F)),
            "w2": _w((lambda *s: torch.randn(*s, dtype=torch.bfloat16) * 0.05)(F, D) * (F ** -0.5)),
        }
    _B_in = _B_setup()

    return {
        "A_u": _A_in["u"],
        "A_A_re": _A_in["A_re"],
        "A_A_im": _A_in["A_im"],
        "A_B_re": _A_in["B_re"],
        "A_B_im": _A_in["B_im"],
        "A_C_re": _A_in["C_re"],
        "A_C_im": _A_in["C_im"],
        "A_log_dt": _A_in["log_dt"],
        "A_Dskip": _A_in["Dskip"],
        "B_x": _B_in["x"],
        "B_w1": _B_in["w1"],
        "B_b1": _B_in["b1"],
        "B_w2": _B_in["w2"],
        "gate_w": _w((lambda *s: torch.randn(*s, dtype=torch.bfloat16) * 0.05)(576) * 16.0),
    }

def reference(A_u, A_A_re, A_A_im, A_B_re, A_B_im, A_C_re, A_C_im, A_log_dt, A_Dskip, B_x, B_w1, B_b1, B_w2, gate_w):
    def _A_ref(u, A_re, A_im, B_re, B_im, C_re, C_im, log_dt, Dskip):
        Bsz, L, D = u.shape
        dt = torch.exp(log_dt)[:, None]
        A = A_re + 1j * A_im
        Bc = B_re + 1j * B_im
        Cc = C_re + 1j * C_im
        logdA = dt * A
        dB = dt * Bc
        l = (lambda x, dt: x.to(dt))(torch.arange(L), A_re.dtype)
        P = torch.exp(logdA[:, :, None] * l[None, None, :])
        K = torch.einsum("dn,dnl,dn->dl", Cc, P, dB).real
        L2 = 2 * L
        Kp = _pad(K, ((0, 0), (0, L)))
        up = (lambda x, *d: x.permute(*d))(u, 0, 2, 1)
        up = _pad(up, ((0, 0), (0, 0), (0, L)))
        Kf = (lambda x, axes=(-2,-1): torch.fft.rfft2(x.float(), dim=axes))(Kp[:, None, :], axes=(-2, -1))
        Uf = (lambda x, axes=(-2,-1): torch.fft.rfft2(x.float(), dim=axes))(up[:, :, None, :], axes=(-2, -1))
        Yf = Uf * Kf[None, :, :, :]
        y = (lambda x, s, axes=(-2,-1): torch.fft.irfft2(x, s=s, dim=axes).to(torch.bfloat16))(Yf, (1, L2), axes=(-2, -1))[:, :, 0, :L]
        y = (lambda x, *d: x.permute(*d))(y, 0, 2, 1) + u * Dskip[None, None, :]
        return y

    def _B_ref(x, w1, b1, w2):
        h = torch.einsum("bsd,df->bsf", x, w1) + b1
        sp = torch.log1p(torch.exp(-torch.abs(h))) + torch.where(h > 0, h, torch.zeros_like(h))
        act = h * torch.tanh(sp)
        return torch.einsum("bsf,fd->bsd", act, w2)

    x = A_u
    g = _sigmoid((x * gate_w).sum(-1, keepdims=True))
    a = _A_ref(x, A_A_re, A_A_im, A_B_re, A_B_im, A_C_re, A_C_im, A_log_dt, A_Dskip)
    b = _B_ref(x, B_w1, B_b1, B_w2)
    return g * a + (1 - g) * b
```

```asm
; @launch grid=(256,1,1) block=(512,1,1) lds=163840
.amdgcn_target "amdgcn-amd-amdhsa--gfx950"
.text
.globl gated_mix__ssm_conv_s4__dense_activation_mish__prompt_kernel
.p2align 8
.type gated_mix__ssm_conv_s4__dense_activation_mish__prompt_kernel,@function
gated_mix__ssm_conv_s4__dense_activation_mish__prompt_kernel:
    s_cmp_ge_u32 s2, 256
    s_cbranch_scc1 L_mainexit
    s_load_dwordx2 s[40:41], s[0:1], 0
    s_load_dwordx4 s[44:47], s[0:1], 80
    s_load_dwordx2 s[48:49], s[0:1], 96
    s_load_dwordx2 s[50:51], s[0:1], 128
    s_load_dwordx4 s[52:55], s[0:1], 112
    v_lshrrev_b32 v1, 6, v0
    v_and_b32 v252, 63, v0
    v_readfirstlane_b32 s24, v1
    s_cmp_lt_u32 s2, 64
    s_cbranch_scc1 L_ssm
L_mlp:
    s_and_b32 s38, s2, 7
    s_lshr_b32 s39, s2, 3
    s_sub_u32 s39, s39, 8
    s_lshr_b32 s26, s38, 1
    s_mul_i32 s26, s26, 3
    s_lshr_b32 s25, s39, 3
    s_add_u32 s26, s26, s25
    s_and_b32 s25, s38, 1
    s_lshl_b32 s25, s25, 3
    s_and_b32 s39, s39, 7
    s_add_u32 s25, s25, s39
    s_and_b32 s27, s24, 3
    s_lshr_b32 s28, s24, 2
    v_lshrrev_b32 v244, 3, v252
    v_and_b32 v246, 7, v252
    s_lshl_b32 s38, s24, 3
    v_add_u32 v247, s38, v244
    v_bfe_u32 v245, v252, 4, 1
    s_and_b32 s38, s24, 1
    s_lshl_b32 s38, s38, 1
    v_or_b32 v245, s38, v245
    v_lshlrev_b32 v245, 1, v245
    v_xor_b32 v245, v245, v246
    v_mul_u32_u24 v248, 9216, v247
    v_lshl_add_u32 v248, v245, 4, v248
    v_bfe_u32 v245, v252, 4, 2
    v_lshlrev_b32 v245, 1, v245
    v_xor_b32 v245, v245, v246
    v_mul_u32_u24 v196, 1152, v247
    v_lshl_add_u32 v196, v245, 4, v196
    s_lshl_b32 s38, s24, 4
    v_add_u32 v247, s38, v244
    v_bfe_u32 v245, v247, 1, 3
    v_xor_b32 v245, v245, v246
    v_mul_u32_u24 v247, 1152, v247
    v_lshl_add_u32 v197, v245, 4, v247
    v_xor_b32 v245, 4, v245
    v_lshl_add_u32 v198, v245, 4, v247
    v_add_u32 v198, 8192, v198
    v_lshrrev_b32 v199, 4, v252
    v_lshlrev_b32 v199, 3, v199
    s_mul_i32 s32, s25, 147456
    s_mul_i32 s30, s26, 768
    s_lshr_b32 s33, s24, 1
    s_lshl_b32 s33, s33, 5
    s_add_u32 s33, s33, s30
    s_lshl_b32 s29, s24, 11
    s_add_u32 s35, s29, 65536
    s_mul_i32 s31, s26, 442368
    s_waitcnt lgkmcnt(0)
    s_mov_b32 s4, s40
    s_and_b32 s5, s41, 0xffff
    s_mov_b32 s6, 2359296
    s_mov_b32 s7, 0x20000
    s_mov_b32 s8, s44
    s_and_b32 s9, s45, 0xffff
    s_mov_b32 s10, 5308416
    s_mov_b32 s11, 0x20000
    s_mov_b32 s16, s46
    s_and_b32 s17, s47, 0xffff
    s_mov_b32 s18, 9216
    s_mov_b32 s19, 0x20000
    s_mov_b32 s12, s48
    s_and_b32 s13, s49, 0xffff
    s_mov_b32 s14, 5308416
    s_mov_b32 s15, 0x20000
    s_mov_b32 s20, s50
    s_and_b32 s21, s51, 0xffff
    s_mov_b32 s22, 32575488
    s_mov_b32 s23, 0x20000
    buffer_load_dwordx2 v[208:209], v199, s[16:19], s33 offen offset:0
    buffer_load_dwordx2 v[210:211], v199, s[16:19], s33 offen offset:128
    buffer_load_dwordx2 v[212:213], v199, s[16:19], s33 offen offset:256
    buffer_load_dwordx2 v[214:215], v199, s[16:19], s33 offen offset:384
    buffer_load_dwordx2 v[216:217], v199, s[16:19], s33 offen offset:512
    buffer_load_dwordx2 v[218:219], v199, s[16:19], s33 offen offset:640
    s_add_u32 m0, s35, 0
    s_nop 0
    buffer_load_dwordx4 v197, s[4:7], s32 offen offset:0 lds
    buffer_load_dwordx4 v198, s[4:7], s32 offen offset:1024 lds
    s_add_u32 m0, s29, 0
    s_nop 0
    buffer_load_dwordx4 v248, s[8:11], s30 offen lds
    s_add_u32 m0, s29, 1024
    s_add_u32 s30, s30, 589824
    buffer_load_dwordx4 v248, s[8:11], s30 offen lds
    s_add_u32 m0, s35, 16256
    s_nop 0
    buffer_load_dwordx4 v197, s[4:7], s32 offen offset:128 lds
    buffer_load_dwordx4 v198, s[4:7], s32 offen offset:1152 lds
    v_lshrrev_b32 v244, 4, v252
    v_bfe_u32 v245, v252, 2, 2
    v_bfe_u32 v246, v252, 3, 2
    s_lshr_b32 s40, s24, 1
    v_xor_b32 v246, s40, v246
    v_lshlrev_b32 v246, 5, v246
    v_and_b32 v247, 3, v252
    v_lshl_add_u32 v246, v247, 3, v246
    v_lshl_add_u32 v246, v245, 7, v246
    v_lshl_add_u32 v194, v244, 11, v246
    v_bfe_u32 v247, v252, 4, 1
    v_lshl_add_u32 v246, v247, 9, v246
    v_lshrrev_b32 v247, 5, v252
    v_lshl_add_u32 v249, v247, 11, v246
    s_and_b32 s41, s24, 1
    s_lshl_b32 s40, s41, 13
    s_add_u32 s40, s40, 65536
    v_lshlrev_b32 v251, 4, v252
    v_add_u32 v250, s40, v251
    s_lshl_b32 s42, s28, 11
    s_bfe_u32 s43, s24, 0x10001
    s_lshl_b32 s43, s43, 3
    s_add_u32 s42, s42, s43
    v_add_u32 v255, s42, v250
    v_add_u32 v240, 65536, v250
    s_lshl_b32 s40, s26, 4
    s_add_u32 s40, s40, s25
    s_lshl_b32 s40, s40, 1
    s_add_u32 s40, s40, s41
    s_lshl_b32 s40, s40, 13
    s_lshr_b32 s41, s24, 1
    s_lshl_b32 s41, s41, 10
    s_add_u32 s34, s40, s41
    s_add_u32 s37, s34, 4096
    v_and_b32 v245, 15, v252
    s_and_b32 s40, s24, 1
    s_lshl_b32 s40, s40, 6
    v_add_u32 v245, s40, v245
    v_bfe_u32 v246, v245, 1, 3
    v_lshlrev_b32 v245, 7, v245
    v_add_u32 v245, 65536, v245
    v_xor_b32 v247, v244, v246
    v_lshl_add_u32 v192, v247, 4, v245
    v_xor_b32 v193, 64, v192
    s_lshl_b32 s40, s25, 7
    s_lshl_b32 s41, s26, 2
    s_add_u32 s40, s40, s41
    s_cmp_eq_u32 s24, 0
    s_cselect_b32 s40, s40, 2146435072
    v_mov_b32 v245, s40
    v_mov_b32 v253, 2146435072
    v_cmp_eq_u32 vcc, 0, v252
    s_mov_b32 s36, 32571392
    s_mov_b32 s56, 0x3fb8aa3b
    s_mov_b32 s57, 0x3f3504f3
    v_mov_b32 v201, 0
    v_mov_b32 v254, 0
    v_cndmask_b32 v253, v253, v245, vcc
    s_add_u32 m0, s35, 32512
    s_nop 0
    buffer_load_dwordx4 v197, s[4:7], s32 offen offset:256 lds
    buffer_load_dwordx4 v198, s[4:7], s32 offen offset:1280 lds
    s_add_u32 m0, s29, 16384
    s_add_u32 s30, s30, 589824
    buffer_load_dwordx4 v248, s[8:11], s30 offen lds
    s_add_u32 m0, s29, 17408
    s_sub_u32 s30, s30, 1179520
    buffer_load_dwordx4 v248, s[8:11], s30 offen lds
    s_waitcnt vmcnt(8)
    v_lshlrev_b32 v0, 16, v208
    v_and_b32 v1, 0xffff0000, v208
    v_lshlrev_b32 v2, 16, v209
    v_and_b32 v3, 0xffff0000, v209
    v_mov_b32 v4, v0
    v_mov_b32 v5, v1
    v_mov_b32 v6, v2
    v_mov_b32 v7, v3
    v_mov_b32 v8, v0
    v_mov_b32 v9, v1
    v_mov_b32 v10, v2
    v_mov_b32 v11, v3
    v_mov_b32 v12, v0
    v_mov_b32 v13, v1
    v_mov_b32 v14, v2
    v_mov_b32 v15, v3
    s_barrier
    ds_read_b128 v[64:67], v192 offset:0
    ds_read_b128 v[68:71], v192 offset:2048
    ds_read_b128 v[72:75], v192 offset:4096
    ds_read_b128 v[76:79], v192 offset:6144
    ds_read_b128 v[80:83], v193 offset:0
    ds_read_b128 v[84:87], v193 offset:2048
    ds_read_b128 v[88:91], v193 offset:4096
    ds_read_b128 v[92:95], v193 offset:6144
    s_add_u32 m0, s29, 32768
    s_add_u32 s30, s30, 589824
    buffer_load_dwordx4 v248, s[8:11], s30 offen lds
    s_add_u32 m0, s29, 33792
    s_add_u32 s30, s30, 589824
    buffer_load_dwordx4 v248, s[8:11], s30 offen lds
    s_waitcnt vmcnt(6) lgkmcnt(0)
    s_barrier
    s_setprio 3
    ds_read_b64_tr_b16 v[224:225], v194 offset:0
    ds_read_b128 v[96:99], v192 offset:16384
    v_lshlrev_b32 v16, 16, v210
    v_and_b32 v17, 0xffff0000, v210
    v_lshlrev_b32 v18, 16, v211
    s_add_u32 m0, s29, 49152
    s_sub_u32 s30, s30, 1179520
    ds_read_b64_tr_b16 v[226:227], v194 offset:512
    buffer_load_dwordx4 v248, s[8:11], s30 offen lds
    ds_read_b128 v[100:103], v192 offset:18432
    s_setprio 2
    ds_read_b64_tr_b16 v[228:229], v194 offset:8192
    ds_read_b128 v[104:107], v192 offset:20480
    v_and_b32 v19, 0xffff0000, v211
    v_mov_b32 v20, v16
    v_mov_b32 v21, v17
    ds_read_b64_tr_b16 v[230:231], v194 offset:8704
    ds_read_b128 v[108:111], v192 offset:22528
    v_mov_b32 v22, v18
    v_mov_b32 v23, v19
    v_mov_b32 v24, v16
    s_setprio 1
    ds_read_b64_tr_b16 v[232:233], v194 offset:1024
    ds_read_b128 v[112:115], v193 offset:16384
    v_mov_b32 v25, v17
    v_mov_b32 v26, v18
    v_mov_b32 v27, v19
    s_add_u32 m0, s29, 50176
    s_add_u32 s30, s30, 589824
    ds_read_b64_tr_b16 v[234:235], v194 offset:1536
    buffer_load_dwordx4 v248, s[8:11], s30 offen lds
    s_waitcnt lgkmcnt(8)
    v_mfma_f32_16x16x32_bf16 v[0:3], v[224:227], v[64:67], v[0:3]
    ds_read_b128 v[116:119], v193 offset:18432
    v_mfma_f32_16x16x32_bf16 v[4:7], v[224:227], v[68:71], v[4:7]
    s_setprio 0
    ds_read_b64_tr_b16 v[236:237], v194 offset:9216
    ds_read_b128 v[120:123], v193 offset:20480
    v_mfma_f32_16x16x32_bf16 v[8:11], v[224:227], v[72:75], v[8:11]
    v_mov_b32 v28, v16
    v_mov_b32 v29, v17
    v_mov_b32 v30, v18
    v_mfma_f32_16x16x32_bf16 v[12:15], v[224:227], v[76:79], v[12:15]
    ds_read_b64_tr_b16 v[238:239], v194 offset:9728
    ds_read_b128 v[124:127], v193 offset:22528
    s_waitcnt lgkmcnt(9)
    v_mfma_f32_16x16x32_bf16 v[0:3], v[228:231], v[80:83], v[0:3]
    v_mov_b32 v31, v19
    v_mfma_f32_16x16x32_bf16 v[4:7], v[228:231], v[84:87], v[4:7]
    s_waitcnt vmcnt(4) lgkmcnt(0)
    s_barrier
    s_setprio 3
    ds_read_b64_tr_b16 v[224:225], v194 offset:16384
    ds_read_b128 v[128:131], v192 offset:32768
    v_mfma_f32_16x16x32_bf16 v[8:11], v[228:231], v[88:91], v[8:11]
    ds_read_b128 v[132:135], v192 offset:34816
    v_mfma_f32_16x16x32_bf16 v[12:15], v[228:231], v[92:95], v[12:15]
    s_add_u32 m0, s29, 0
    s_add_u32 s30, s30, 589824
    ds_read_b64_tr_b16 v[226:227], v194 offset:16896
    buffer_load_dwordx4 v248, s[8:11], s30 offen lds
    v_mfma_f32_16x16x32_bf16 v[0:3], v[232:235], v[96:99], v[0:3]
    ds_read_b128 v[136:139], v192 offset:36864
    ds_read_b128 v[140:143], v192 offset:38912
    v_mfma_f32_16x16x32_bf16 v[4:7], v[232:235], v[100:103], v[4:7]
    s_setprio 2
    ds_read_b64_tr_b16 v[228:229], v194 offset:24576
    ds_read_b128 v[144:147], v193 offset:32768
    v_mfma_f32_16x16x32_bf16 v[8:11], v[232:235], v[104:107], v[8:11]
    ds_read_b128 v[148:151], v193 offset:34816
    v_mfma_f32_16x16x32_bf16 v[12:15], v[232:235], v[108:111], v[12:15]
    ds_read_b64_tr_b16 v[230:231], v194 offset:25088
    ds_read_b128 v[152:155], v193 offset:36864
    v_mfma_f32_16x16x32_bf16 v[0:3], v[236:239], v[112:115], v[0:3]
    ds_read_b128 v[156:159], v193 offset:38912
    v_mfma_f32_16x16x32_bf16 v[4:7], v[236:239], v[116:119], v[4:7]
    s_setprio 1
    ds_read_b64_tr_b16 v[232:233], v194 offset:17408
    v_mfma_f32_16x16x32_bf16 v[8:11], v[236:239], v[120:123], v[8:11]
    v_lshlrev_b32 v32, 16, v212
    v_and_b32 v33, 0xffff0000, v212
    v_mfma_f32_16x16x32_bf16 v[12:15], v[236:239], v[124:127], v[12:15]
    s_add_u32 m0, s29, 1024
    s_sub_u32 s30, s30, 1179520
    ds_read_b64_tr_b16 v[234:235], v194 offset:17920
    s_waitcnt lgkmcnt(10)
    v_mfma_f32_16x16x32_bf16 v[0:3], v[224:227], v[128:131], v[0:3]
    buffer_load_dwordx4 v248, s[8:11], s30 offen lds
    v_mfma_f32_16x16x32_bf16 v[4:7], v[224:227], v[132:135], v[4:7]
    s_setprio 0
    ds_read_b64_tr_b16 v[236:237], v194 offset:25600
    s_waitcnt lgkmcnt(9)
    v_mfma_f32_16x16x32_bf16 v[8:11], v[224:227], v[136:139], v[8:11]
    v_lshlrev_b32 v34, 16, v213
    v_and_b32 v35, 0xffff0000, v213
    v_mfma_f32_16x16x32_bf16 v[12:15], v[224:227], v[140:143], v[12:15]
    ds_read_b64_tr_b16 v[238:239], v194 offset:26112
    s_waitcnt lgkmcnt(6)
    v_mfma_f32_16x16x32_bf16 v[0:3], v[228:231], v[144:147], v[0:3]
    v_mov_b32 v36, v32
    v_mov_b32 v37, v33
    v_mfma_f32_16x16x32_bf16 v[4:7], v[228:231], v[148:151], v[4:7]
    s_waitcnt vmcnt(4) lgkmcnt(0)
    s_barrier
    s_setprio 3
    ds_read_b64_tr_b16 v[224:225], v194 offset:32768
    v_mfma_f32_16x16x32_bf16 v[8:11], v[228:231], v[152:155], v[8:11]
    v_mov_b32 v38, v34
    v_mov_b32 v39, v35
    v_mfma_f32_16x16x32_bf16 v[12:15], v[228:231], v[156:159], v[12:15]
    s_add_u32 m0, s29, 16384
    s_add_u32 s30, s30, 589824
    ds_read_b64_tr_b16 v[226:227], v194 offset:33280
    v_mfma_f32_16x16x32_bf16 v[16:19], v[232:235], v[64:67], v[16:19]
    buffer_load_dwordx4 v248, s[8:11], s30 offen lds
    v_mfma_f32_16x16x32_bf16 v[20:23], v[232:235], v[68:71], v[20:23]
    s_setprio 2
    ds_read_b64_tr_b16 v[228:229], v194 offset:40960
    v_mfma_f32_16x16x32_bf16 v[24:27], v[232:235], v[72:75], v[24:27]
    v_mov_b32 v40, v32
    v_mov_b32 v41, v33
    v_mfma_f32_16x16x32_bf16 v[28:31], v[232:235], v[76:79], v[28:31]
    ds_read_b64_tr_b16 v[230:231], v194 offset:41472
    s_add_u32 m0, s35, 48768
    s_nop 0
    buffer_load_dwordx4 v197, s[4:7], s32 offen offset:384 lds
    buffer_load_dwordx4 v198, s[4:7], s32 offen offset:1408 lds
    v_mfma_f32_16x16x32_bf16 v[16:19], v[236:239], v[80:83], v[16:19]
    v_mov_b32 v42, v34
    v_mov_b32 v43, v35
    v_mfma_f32_16x16x32_bf16 v[20:23], v[236:239], v[84:87], v[20:23]
    s_setprio 1
    ds_read_b64_tr_b16 v[232:233], v194 offset:33792
    v_mfma_f32_16x16x32_bf16 v[24:27], v[236:239], v[88:91], v[24:27]
    v_mov_b32 v44, v32
    v_mov_b32 v45, v33
    v_mfma_f32_16x16x32_bf16 v[28:31], v[236:239], v[92:95], v[28:31]
    s_add_u32 m0, s29, 17408
    s_add_u32 s30, s30, 589824
    ds_read_b64_tr_b16 v[234:235], v194 offset:34304
    s_waitcnt lgkmcnt(4)
    v_mfma_f32_16x16x32_bf16 v[16:19], v[224:227], v[96:99], v[16:19]
    buffer_load_dwordx4 v248, s[8:11], s30 offen lds
    v_mfma_f32_16x16x32_bf16 v[20:23], v[224:227], v[100:103], v[20:23]
    s_setprio 0
    ds_read_b64_tr_b16 v[236:237], v194 offset:41984
    v_mfma_f32_16x16x32_bf16 v[24:27], v[224:227], v[104:107], v[24:27]
    v_mov_b32 v46, v34
    v_mov_b32 v47, v35
    v_mfma_f32_16x16x32_bf16 v[28:31], v[224:227], v[108:111], v[28:31]
    ds_read_b64_tr_b16 v[238:239], v194 offset:42496
    s_waitcnt lgkmcnt(4)
    v_mfma_f32_16x16x32_bf16 v[16:19], v[228:231], v[112:115], v[16:19]
    v_mfma_f32_16x16x32_bf16 v[20:23], v[228:231], v[116:119], v[20:23]
    s_waitcnt vmcnt(6) lgkmcnt(0)
    s_barrier
    s_setprio 3
    ds_read_b64_tr_b16 v[224:225], v194 offset:49152
    v_mfma_f32_16x16x32_bf16 v[24:27], v[228:231], v[120:123], v[24:27]
    v_lshlrev_b32 v48, 16, v214
    v_and_b32 v49, 0xffff0000, v214
    v_mfma_f32_16x16x32_bf16 v[28:31], v[228:231], v[124:127], v[28:31]
    s_add_u32 m0, s29, 32768
    s_sub_u32 s30, s30, 1179520
    ds_read_b64_tr_b16 v[226:227], v194 offset:49664
    v_mfma_f32_16x16x32_bf16 v[16:19], v[232:235], v[128:131], v[16:19]
    buffer_load_dwordx4 v248, s[8:11], s30 offen lds
    v_mfma_f32_16x16x32_bf16 v[20:23], v[232:235], v[132:135], v[20:23]
    s_setprio 2
    ds_read_b64_tr_b16 v[228:229], v194 offset:57344
    v_mfma_f32_16x16x32_bf16 v[24:27], v[232:235], v[136:139], v[24:27]
    v_lshlrev_b32 v50, 16, v215
    v_and_b32 v51, 0xffff0000, v215
    v_mfma_f32_16x16x32_bf16 v[28:31], v[232:235], v[140:143], v[28:31]
    ds_read_b64_tr_b16 v[230:231], v194 offset:57856
    s_add_u32 m0, s35, 65024
    s_nop 0
    buffer_load_dwordx4 v197, s[4:7], s32 offen offset:512 lds
    buffer_load_dwordx4 v198, s[4:7], s32 offen offset:1536 lds
    v_mfma_f32_16x16x32_bf16 v[16:19], v[236:239], v[144:147], v[16:19]
    v_mov_b32 v52, v48
    v_mov_b32 v53, v49
    v_mfma_f32_16x16x32_bf16 v[20:23], v[236:239], v[148:151], v[20:23]
    s_setprio 1
    ds_read_b64_tr_b16 v[232:233], v194 offset:50176
    v_mfma_f32_16x16x32_bf16 v[24:27], v[236:239], v[152:155], v[24:27]
    v_mov_b32 v54, v50
    v_mov_b32 v55, v51
    v_mfma_f32_16x16x32_bf16 v[28:31], v[236:239], v[156:159], v[28:31]
    s_add_u32 m0, s29, 33792
    s_add_u32 s30, s30, 589824
    ds_read_b64_tr_b16 v[234:235], v194 offset:50688
    s_waitcnt lgkmcnt(4)
    v_mfma_f32_16x16x32_bf16 v[32:35], v[224:227], v[64:67], v[32:35]
    buffer_load_dwordx4 v248, s[8:11], s30 offen lds
    v_mfma_f32_16x16x32_bf16 v[36:39], v[224:227], v[68:71], v[36:39]
    s_setprio 0
    ds_read_b64_tr_b16 v[236:237], v194 offset:58368
    v_mfma_f32_16x16x32_bf16 v[40:43], v[224:227], v[72:75], v[40:43]
    v_mov_b32 v56, v48
    v_mov_b32 v57, v49
    v_mfma_f32_16x16x32_bf16 v[44:47], v[224:227], v[76:79], v[44:47]
    ds_read_b64_tr_b16 v[238:239], v194 offset:58880
    s_waitcnt lgkmcnt(4)
    v_mfma_f32_16x16x32_bf16 v[32:35], v[228:231], v[80:83], v[32:35]
    v_mov_b32 v58, v50
    v_mov_b32 v59, v51
    v_mfma_f32_16x16x32_bf16 v[36:39], v[228:231], v[84:87], v[36:39]
    s_waitcnt vmcnt(8) lgkmcnt(0)
    s_barrier
    s_setprio 3
    ds_read_b64_tr_b16 v[224:225], v194 offset:0
    v_mfma_f32_16x16x32_bf16 v[40:43], v[228:231], v[88:91], v[40:43]
    v_mov_b32 v60, v48
    v_mov_b32 v61, v49
    v_mfma_f32_16x16x32_bf16 v[44:47], v[228:231], v[92:95], v[44:47]
    s_add_u32 m0, s29, 49152
    s_add_u32 s30, s30, 589824
    ds_read_b64_tr_b16 v[226:227], v194 offset:512
    v_mfma_f32_16x16x32_bf16 v[32:35], v[232:235], v[96:99], v[32:35]
    buffer_load_dwordx4 v248, s[8:11], s30 offen lds
    v_mfma_f32_16x16x32_bf16 v[36:39], v[232:235], v[100:103], v[36:39]
    s_setprio 2
    ds_read_b64_tr_b16 v[228:229], v194 offset:8192
    v_mfma_f32_16x16x32_bf16 v[40:43], v[232:235], v[104:107], v[40:43]
    v_mov_b32 v62, v50
    v_mov_b32 v63, v51
    v_mfma_f32_16x16x32_bf16 v[44:47], v[232:235], v[108:111], v[44:47]
    ds_read_b64_tr_b16 v[230:231], v194 offset:8704
    s_add_u32 m0, s35, 81280
    s_nop 0
    buffer_load_dwordx4 v197, s[4:7], s32 offen offset:640 lds
    buffer_load_dwordx4 v198, s[4:7], s32 offen offset:1664 lds
    v_mfma_f32_16x16x32_bf16 v[32:35], v[236:239], v[112:115], v[32:35]
    v_mfma_f32_16x16x32_bf16 v[36:39], v[236:239], v[116:119], v[36:39]
    s_setprio 1
    ds_read_b64_tr_b16 v[232:233], v194 offset:1024
    v_mfma_f32_16x16x32_bf16 v[40:43], v[236:239], v[120:123], v[40:43]
    v_lshlrev_b32 v160, 16, v216
    v_and_b32 v161, 0xffff0000, v216
    v_mfma_f32_16x16x32_bf16 v[44:47], v[236:239], v[124:127], v[44:47]
    s_add_u32 m0, s29, 50176
    s_sub_u32 s30, s30, 1179520
    ds_read_b64_tr_b16 v[234:235], v194 offset:1536
    s_waitcnt lgkmcnt(4)
    v_mfma_f32_16x16x32_bf16 v[32:35], v[224:227], v[128:131], v[32:35]
    buffer_load_dwordx4 v248, s[8:11], s30 offen lds
    v_mfma_f32_16x16x32_bf16 v[36:39], v[224:227], v[132:135], v[36:39]
    s_setprio 0
    ds_read_b64_tr_b16 v[236:237], v194 offset:9216
    v_mfma_f32_16x16x32_bf16 v[40:43], v[224:227], v[136:139], v[40:43]
    v_lshlrev_b32 v162, 16, v217
    v_and_b32 v163, 0xffff0000, v217
    v_mfma_f32_16x16x32_bf16 v[44:47], v[224:227], v[140:143], v[44:47]
    ds_read_b64_tr_b16 v[238:239], v194 offset:9728
    s_waitcnt lgkmcnt(4)
    v_mfma_f32_16x16x32_bf16 v[32:35], v[228:231], v[144:147], v[32:35]
    v_mov_b32 v164, v160
    v_mov_b32 v165, v161
    v_mfma_f32_16x16x32_bf16 v[36:39], v[228:231], v[148:151], v[36:39]
    s_waitcnt vmcnt(8) lgkmcnt(0)
    s_barrier
    s_setprio 3
    ds_read_b64_tr_b16 v[224:225], v194 offset:16384
    v_mfma_f32_16x16x32_bf16 v[40:43], v[228:231], v[152:155], v[40:43]
    v_mov_b32 v166, v162
    v_mov_b32 v167, v163
    v_mfma_f32_16x16x32_bf16 v[44:47], v[228:231], v[156:159], v[44:47]
    s_add_u32 m0, s29, 0
    s_add_u32 s30, s30, 589824
    ds_read_b64_tr_b16 v[226:227], v194 offset:16896
    v_mfma_f32_16x16x32_bf16 v[48:51], v[232:235], v[64:67], v[48:51]
    buffer_load_dwordx4 v248, s[8:11], s30 offen lds
    v_mfma_f32_16x16x32_bf16 v[52:55], v[232:235], v[68:71], v[52:55]
    s_setprio 2
    ds_read_b64_tr_b16 v[228:229], v194 offset:24576
    v_mfma_f32_16x16x32_bf16 v[56:59], v[232:235], v[72:75], v[56:59]
    v_mov_b32 v168, v160
    v_mov_b32 v169, v161
    v_mfma_f32_16x16x32_bf16 v[60:63], v[232:235], v[76:79], v[60:63]
    ds_read_b64_tr_b16 v[230:231], v194 offset:25088
    v_mfma_f32_16x16x32_bf16 v[48:51], v[236:239], v[80:83], v[48:51]
    v_mov_b32 v170, v162
    v_mov_b32 v171, v163
    v_mfma_f32_16x16x32_bf16 v[52:55], v[236:239], v[84:87], v[52:55]
    s_setprio 1
    ds_read_b64_tr_b16 v[232:233], v194 offset:17408
    v_mfma_f32_16x16x32_bf16 v[56:59], v[236:239], v[88:91], v[56:59]
    v_mov_b32 v172, v160
    v_mov_b32 v173, v161
    v_mfma_f32_16x16x32_bf16 v[60:63], v[236:239], v[92:95], v[60:63]
    s_add_u32 m0, s29, 1024
    s_add_u32 s30, s30, 589824
    ds_read_b64_tr_b16 v[234:235], v194 offset:17920
    s_waitcnt lgkmcnt(4)
    v_mfma_f32_16x16x32_bf16 v[48:51], v[224:227], v[96:99], v[48:51]
    buffer_load_dwordx4 v248, s[8:11], s30 offen lds
    v_mfma_f32_16x16x32_bf16 v[52:55], v[224:227], v[100:103], v[52:55]
    s_setprio 0
    ds_read_b64_tr_b16 v[236:237], v194 offset:25600
    v_mfma_f32_16x16x32_bf16 v[56:59], v[224:227], v[104:107], v[56:59]
    v_mov_b32 v174, v162
    v_mov_b32 v175, v163
    v_mfma_f32_16x16x32_bf16 v[60:63], v[224:227], v[108:111], v[60:63]
    ds_read_b64_tr_b16 v[238:239], v194 offset:26112
    s_waitcnt lgkmcnt(4)
    v_mfma_f32_16x16x32_bf16 v[48:51], v[228:231], v[112:115], v[48:51]
    v_mfma_f32_16x16x32_bf16 v[52:55], v[228:231], v[116:119], v[52:55]
    s_waitcnt vmcnt(6) lgkmcnt(0)
    s_barrier
    s_setprio 3
    ds_read_b64_tr_b16 v[224:225], v194 offset:32768
    v_mfma_f32_16x16x32_bf16 v[56:59], v[228:231], v[120:123], v[56:59]
    v_lshlrev_b32 v176, 16, v218
    v_and_b32 v177, 0xffff0000, v218
    v_mfma_f32_16x16x32_bf16 v[60:63], v[228:231], v[124:127], v[60:63]
    s_add_u32 m0, s29, 16384
    s_add_u32 s30, s30, 589184
    ds_read_b64_tr_b16 v[226:227], v194 offset:33280
    v_mfma_f32_16x16x32_bf16 v[48:51], v[232:235], v[128:131], v[48:51]
    buffer_load_dwordx4 v248, s[8:11], s30 offen lds
    v_mfma_f32_16x16x32_bf16 v[52:55], v[232:235], v[132:135], v[52:55]
    s_setprio 2
    ds_read_b64_tr_b16 v[228:229], v194 offset:40960
    v_mfma_f32_16x16x32_bf16 v[56:59], v[232:235], v[136:139], v[56:59]
    v_lshlrev_b32 v178, 16, v219
    v_and_b32 v179, 0xffff0000, v219
    v_mfma_f32_16x16x32_bf16 v[60:63], v[232:235], v[140:143], v[60:63]
    ds_read_b64_tr_b16 v[230:231], v194 offset:41472
    v_mfma_f32_16x16x32_bf16 v[48:51], v[236:239], v[144:147], v[48:51]
    v_mov_b32 v180, v176
    v_mov_b32 v181, v177
    v_mfma_f32_16x16x32_bf16 v[52:55], v[236:239], v[148:151], v[52:55]
    s_setprio 1
    ds_read_b64_tr_b16 v[232:233], v194 offset:33792
    v_mfma_f32_16x16x32_bf16 v[56:59], v[236:239], v[152:155], v[56:59]
    v_mov_b32 v182, v178
    v_mov_b32 v183, v179
    v_mfma_f32_16x16x32_bf16 v[60:63], v[236:239], v[156:159], v[60:63]
    s_add_u32 m0, s29, 17408
    s_add_u32 s30, s30, 589824
    ds_read_b64_tr_b16 v[234:235], v194 offset:34304
    s_waitcnt lgkmcnt(4)
    v_mfma_f32_16x16x32_bf16 v[160:163], v[224:227], v[64:67], v[160:163]
    buffer_load_dwordx4 v248, s[8:11], s30 offen lds
    v_mfma_f32_16x16x32_bf16 v[164:167], v[224:227], v[68:71], v[164:167]
    s_setprio 0
    ds_read_b64_tr_b16 v[236:237], v194 offset:41984
    v_mfma_f32_16x16x32_bf16 v[168:171], v[224:227], v[72:75], v[168:171]
    v_mov_b32 v184, v176
    v_mov_b32 v185, v177
    v_mfma_f32_16x16x32_bf16 v[172:175], v[224:227], v[76:79], v[172:175]
    ds_read_b64_tr_b16 v[238:239], v194 offset:42496
    s_waitcnt lgkmcnt(4)
    v_mfma_f32_16x16x32_bf16 v[160:163], v[228:231], v[80:83], v[160:163]
    v_mov_b32 v186, v178
    v_mov_b32 v187, v179
    v_mfma_f32_16x16x32_bf16 v[164:167], v[228:231], v[84:87], v[164:167]
    s_waitcnt vmcnt(4) lgkmcnt(0)
    s_barrier
    s_setprio 3
    ds_read_b64_tr_b16 v[224:225], v194 offset:49152
    v_mfma_f32_16x16x32_bf16 v[168:171], v[228:231], v[88:91], v[168:171]
    v_mov_b32 v188, v176
    v_mov_b32 v189, v177
    v_mfma_f32_16x16x32_bf16 v[172:175], v[228:231], v[92:95], v[172:175]
    s_add_u32 m0, s29, 32768
    s_add_u32 s30, s30, 589824
    ds_read_b64_tr_b16 v[226:227], v194 offset:49664
    v_mfma_f32_16x16x32_bf16 v[160:163], v[232:235], v[96:99], v[160:163]
    buffer_load_dwordx4 v248, s[8:11], s30 offen lds
    v_mfma_f32_16x16x32_bf16 v[164:167], v[232:235], v[100:103], v[164:167]
    s_setprio 2
    ds_read_b64_tr_b16 v[228:229], v194 offset:57344
    v_mfma_f32_16x16x32_bf16 v[168:171], v[232:235], v[104:107], v[168:171]
    v_mov_b32 v190, v178
    v_mov_b32 v191, v179
    v_mfma_f32_16x16x32_bf16 v[172:175], v[232:235], v[108:111], v[172:175]
    ds_read_b64_tr_b16 v[230:231], v194 offset:57856
    v_mfma_f32_16x16x32_bf16 v[160:163], v[236:239], v[112:115], v[160:163]
    v_mfma_f32_16x16x32_bf16 v[164:167], v[236:239], v[116:119], v[164:167]
    s_setprio 1
    ds_read_b64_tr_b16 v[232:233], v194 offset:50176
    v_mfma_f32_16x16x32_bf16 v[168:171], v[236:239], v[120:123], v[168:171]
    v_mfma_f32_16x16x32_bf16 v[172:175], v[236:239], v[124:127], v[172:175]
    s_add_u32 m0, s29, 33792
    s_sub_u32 s30, s30, 1179520
    ds_read_b64_tr_b16 v[234:235], v194 offset:50688
    s_waitcnt lgkmcnt(4)
    v_mfma_f32_16x16x32_bf16 v[160:163], v[224:227], v[128:131], v[160:163]
    buffer_load_dwordx4 v248, s[8:11], s30 offen lds
    v_mfma_f32_16x16x32_bf16 v[164:167], v[224:227], v[132:135], v[164:167]
    s_setprio 0
    ds_read_b64_tr_b16 v[236:237], v194 offset:58368
    v_mfma_f32_16x16x32_bf16 v[168:171], v[224:227], v[136:139], v[168:171]
    v_mfma_f32_16x16x32_bf16 v[172:175], v[224:227], v[140:143], v[172:175]
    ds_read_b64_tr_b16 v[238:239], v194 offset:58880
    s_waitcnt lgkmcnt(4)
    v_mfma_f32_16x16x32_bf16 v[160:163], v[228:231], v[144:147], v[160:163]
    v_mfma_f32_16x16x32_bf16 v[164:167], v[228:231], v[148:151], v[164:167]
    s_waitcnt vmcnt(4) lgkmcnt(0)
    s_barrier
    s_setprio 3
    ds_read_b64_tr_b16 v[224:225], v194 offset:0
    v_mfma_f32_16x16x32_bf16 v[168:171], v[228:231], v[152:155], v[168:171]
    v_mfma_f32_16x16x32_bf16 v[172:175], v[228:231], v[156:159], v[172:175]
    s_add_u32 m0, s29, 49152
    s_add_u32 s30, s30, 589824
    ds_read_b64_tr_b16 v[226:227], v194 offset:512
    v_mfma_f32_16x16x32_bf16 v[176:179], v[232:235], v[64:67], v[176:179]
    buffer_load_dwordx4 v248, s[8:11], s30 offen lds
    v_mfma_f32_16x16x32_bf16 v[180:183], v[232:235], v[68:71], v[180:183]
    s_setprio 2
    ds_read_b64_tr_b16 v[228:229], v194 offset:8192
    v_mfma_f32_16x16x32_bf16 v[184:187], v[232:235], v[72:75], v[184:187]
    v_mfma_f32_16x16x32_bf16 v[188:191], v[232:235], v[76:79], v[188:191]
    ds_read_b64_tr_b16 v[230:231], v194 offset:8704
    ds_read_b128 v[64:67], v192 offset:49152
    v_mfma_f32_16x16x32_bf16 v[176:179], v[236:239], v[80:83], v[176:179]
    ds_read_b128 v[68:71], v192 offset:51200
    v_mfma_f32_16x16x32_bf16 v[180:183], v[236:239], v[84:87], v[180:183]
    s_setprio 1
    ds_read_b64_tr_b16 v[232:233], v194 offset:1024
    ds_read_b128 v[72:75], v192 offset:53248
    v_mfma_f32_16x16x32_bf16 v[184:187], v[236:239], v[88:91], v[184:187]
    ds_read_b128 v[76:79], v192 offset:55296
    v_mfma_f32_16x16x32_bf16 v[188:191], v[236:239], v[92:95], v[188:191]
    s_add_u32 m0, s29, 50176
    s_add_u32 s30, s30, 589824
    ds_read_b64_tr_b16 v[234:235], v194 offset:1536
    buffer_load_dwordx4 v248, s[8:11], s30 offen lds
    s_waitcnt lgkmcnt(8)
    v_mfma_f32_16x16x32_bf16 v[176:179], v[224:227], v[96:99], v[176:179]
    ds_read_b128 v[80:83], v193 offset:49152
    ds_read_b128 v[84:87], v193 offset:51200
    v_mfma_f32_16x16x32_bf16 v[180:183], v[224:227], v[100:103], v[180:183]
    s_setprio 0
    ds_read_b64_tr_b16 v[236:237], v194 offset:9216
    ds_read_b128 v[88:91], v193 offset:53248
    v_mfma_f32_16x16x32_bf16 v[184:187], v[224:227], v[104:107], v[184:187]
    ds_read_b128 v[92:95], v193 offset:55296
    v_mfma_f32_16x16x32_bf16 v[188:191], v[224:227], v[108:111], v[188:191]
    ds_read_b64_tr_b16 v[238:239], v194 offset:9728
    v_add_u32 v192, 32768, v192
    v_add_u32 v193, 32768, v193
    ds_read_b128 v[96:99], v192 offset:32768
    s_waitcnt lgkmcnt(13)
    v_mfma_f32_16x16x32_bf16 v[176:179], v[228:231], v[112:115], v[176:179]
    ds_read_b128 v[100:103], v192 offset:34816
    v_mfma_f32_16x16x32_bf16 v[180:183], v[228:231], v[116:119], v[180:183]
    s_waitcnt vmcnt(4) lgkmcnt(0)
    s_barrier
    s_setprio 3
    ds_read_b64_tr_b16 v[224:225], v194 offset:16384
    ds_read_b128 v[104:107], v192 offset:36864
    v_mfma_f32_16x16x32_bf16 v[184:187], v[228:231], v[120:123], v[184:187]
    ds_read_b128 v[108:111], v192 offset:38912
    v_mfma_f32_16x16x32_bf16 v[188:191], v[228:231], v[124:127], v[188:191]
    s_add_u32 m0, s29, 0
    s_sub_u32 s30, s30, 1179520
    ds_read_b64_tr_b16 v[226:227], v194 offset:16896
    buffer_load_dwordx4 v248, s[8:11], s30 offen lds
    v_mfma_f32_16x16x32_bf16 v[176:179], v[232:235], v[128:131], v[176:179]
    ds_read_b128 v[112:115], v193 offset:32768
    ds_read_b128 v[116:119], v193 offset:34816
    v_mfma_f32_16x16x32_bf16 v[180:183], v[232:235], v[132:135], v[180:183]
    s_setprio 2
    ds_read_b64_tr_b16 v[228:229], v194 offset:24576
    ds_read_b128 v[120:123], v193 offset:36864
    v_mfma_f32_16x16x32_bf16 v[184:187], v[232:235], v[136:139], v[184:187]
    ds_read_b128 v[124:127], v193 offset:38912
    v_mfma_f32_16x16x32_bf16 v[188:191], v[232:235], v[140:143], v[188:191]
    ds_read_b64_tr_b16 v[230:231], v194 offset:25088
    s_add_u32 m0, s35, -768
    s_nop 0
    buffer_load_dwordx4 v197, s[4:7], s32 offen offset:768 lds
    buffer_load_dwordx4 v198, s[4:7], s32 offen offset:1792 lds
    v_mfma_f32_16x16x32_bf16 v[176:179], v[236:239], v[144:147], v[176:179]
    ds_read_b128 v[128:131], v192 offset:49152
    ds_read_b128 v[132:135], v192 offset:51200
    v_mfma_f32_16x16x32_bf16 v[180:183], v[236:239], v[148:151], v[180:183]
    s_setprio 1
    ds_read_b64_tr_b16 v[232:233], v194 offset:17408
    ds_read_b128 v[136:139], v192 offset:53248
    v_mfma_f32_16x16x32_bf16 v[184:187], v[236:239], v[152:155], v[184:187]
    ds_read_b128 v[140:143], v192 offset:55296
    v_mfma_f32_16x16x32_bf16 v[188:191], v[236:239], v[156:159], v[188:191]
    s_add_u32 m0, s29, 1024
    s_add_u32 s30, s30, 589824
    s_waitcnt lgkmcnt(13)
    ds_read_b64_tr_b16 v[234:235], v194 offset:17920
    buffer_load_dwordx4 v248, s[8:11], s30 offen lds
    s_waitcnt lgkmcnt(12)
    v_mfma_f32_16x16x32_bf16 v[0:3], v[224:227], v[64:67], v[0:3]
    ds_read_b128 v[144:147], v193 offset:49152
    ds_read_b128 v[148:151], v193 offset:51200
    v_mfma_f32_16x16x32_bf16 v[4:7], v[224:227], v[68:71], v[4:7]
    s_setprio 0
    ds_read_b64_tr_b16 v[236:237], v194 offset:25600
    s_waitcnt lgkmcnt(13)
    ds_read_b128 v[152:155], v193 offset:53248
    v_mfma_f32_16x16x32_bf16 v[8:11], v[224:227], v[72:75], v[8:11]
    ds_read_b128 v[156:159], v193 offset:55296
    v_mfma_f32_16x16x32_bf16 v[12:15], v[224:227], v[76:79], v[12:15]
    s_waitcnt lgkmcnt(13)
    ds_read_b64_tr_b16 v[238:239], v194 offset:26112
    s_waitcnt lgkmcnt(12)
    v_mfma_f32_16x16x32_bf16 v[0:3], v[228:231], v[80:83], v[0:3]
    v_mfma_f32_16x16x32_bf16 v[4:7], v[228:231], v[84:87], v[4:7]
    s_waitcnt vmcnt(6) lgkmcnt(0)
    s_barrier
    s_setprio 3
    ds_read_b64_tr_b16 v[224:225], v194 offset:32768
    v_mfma_f32_16x16x32_bf16 v[8:11], v[228:231], v[88:91], v[8:11]
    v_mfma_f32_16x16x32_bf16 v[12:15], v[228:231], v[92:95], v[12:15]
    s_add_u32 m0, s29, 16384
    s_add_u32 s30, s30, 589824
    ds_read_b64_tr_b16 v[226:227], v194 offset:33280
    v_mfma_f32_16x16x32_bf16 v[0:3], v[232:235], v[96:99], v[0:3]
    buffer_load_dwordx4 v248, s[8:11], s30 offen lds
    v_mfma_f32_16x16x32_bf16 v[4:7], v[232:235], v[100:103], v[4:7]
    s_setprio 2
    ds_read_b64_tr_b16 v[228:229], v194 offset:40960
    v_mfma_f32_16x16x32_bf16 v[8:11], v[232:235], v[104:107], v[8:11]
    v_mfma_f32_16x16x32_bf16 v[12:15], v[232:235], v[108:111], v[12:15]
    ds_read_b64_tr_b16 v[230:231], v194 offset:41472
    s_add_u32 m0, s35, 15488
    s_nop 0
    buffer_load_dwordx4 v197, s[4:7], s32 offen offset:896 lds
    buffer_load_dwordx4 v198, s[4:7], s32 offen offset:1920 lds
    v_mfma_f32_16x16x32_bf16 v[0:3], v[236:239], v[112:115], v[0:3]
    v_mfma_f32_16x16x32_bf16 v[4:7], v[236:239], v[116:119], v[4:7]
    s_setprio 1
    ds_read_b64_tr_b16 v[232:233], v194 offset:33792
    v_mfma_f32_16x16x32_bf16 v[8:11], v[236:239], v[120:123], v[8:11]
    v_mfma_f32_16x16x32_bf16 v[12:15], v[236:239], v[124:127], v[12:15]
    s_add_u32 m0, s29, 17408
    s_sub_u32 s30, s30, 1179520
    ds_read_b64_tr_b16 v[234:235], v194 offset:34304
    s_waitcnt lgkmcnt(4)
    v_mfma_f32_16x16x32_bf16 v[0:3], v[224:227], v[128:131], v[0:3]
    buffer_load_dwordx4 v248, s[8:11], s30 offen lds
    v_mfma_f32_16x16x32_bf16 v[4:7], v[224:227], v[132:135], v[4:7]
    s_setprio 0
    ds_read_b64_tr_b16 v[236:237], v194 offset:41984
    v_mfma_f32_16x16x32_bf16 v[8:11], v[224:227], v[136:139], v[8:11]
    v_mfma_f32_16x16x32_bf16 v[12:15], v[224:227], v[140:143], v[12:15]
    ds_read_b64_tr_b16 v[238:239], v194 offset:42496
    s_waitcnt lgkmcnt(4)
    v_mfma_f32_16x16x32_bf16 v[0:3], v[228:231], v[144:147], v[0:3]
    v_mfma_f32_16x16x32_bf16 v[4:7], v[228:231], v[148:151], v[4:7]
    s_waitcnt vmcnt(8) lgkmcnt(0)
    s_barrier
    s_setprio 3
    ds_read_b64_tr_b16 v[224:225], v194 offset:49152
    v_mfma_f32_16x16x32_bf16 v[8:11], v[228:231], v[152:155], v[8:11]
    v_mfma_f32_16x16x32_bf16 v[12:15], v[228:231], v[156:159], v[12:15]
    s_add_u32 m0, s29, 32768
    s_add_u32 s30, s30, 589824
    ds_read_b64_tr_b16 v[226:227], v194 offset:49664
    v_mfma_f32_16x16x32_bf16 v[16:19], v[232:235], v[64:67], v[16:19]
    buffer_load_dwordx4 v248, s[8:11], s30 offen lds
    v_mfma_f32_16x16x32_bf16 v[20:23], v[232:235], v[68:71], v[20:23]
    s_setprio 2
    ds_read_b64_tr_b16 v[228:229], v194 offset:57344
    v_mfma_f32_16x16x32_bf16 v[24:27], v[232:235], v[72:75], v[24:27]
    v_mfma_f32_16x16x32_bf16 v[28:31], v[232:235], v[76:79], v[28:31]
    ds_read_b64_tr_b16 v[230:231], v194 offset:57856
    s_add_u32 m0, s35, 31744
    s_nop 0
    buffer_load_dwordx4 v197, s[4:7], s32 offen offset:1024 lds
    buffer_load_dwordx4 v198, s[4:7], s32 offen offset:2048 lds
    v_mfma_f32_16x16x32_bf16 v[16:19], v[236:239], v[80:83], v[16:19]
    v_mfma_f32_16x16x32_bf16 v[20:23], v[236:239], v[84:87], v[20:23]
    s_setprio 1
    ds_read_b64_tr_b16 v[232:233], v194 offset:50176
    v_mfma_f32_16x16x32_bf16 v[24:27], v[236:239], v[88:91], v[24:27]
    v_mfma_f32_16x16x32_bf16 v[28:31], v[236:239], v[92:95], v[28:31]
    s_add_u32 m0, s29, 33792
    s_add_u32 s30, s30, 589824
    ds_read_b64_tr_b16 v[234:235], v194 offset:50688
    s_waitcnt lgkmcnt(4)
    v_mfma_f32_16x16x32_bf16 v[16:19], v[224:227], v[96:99], v[16:19]
    buffer_load_dwordx4 v248, s[8:11], s30 offen lds
    v_mfma_f32_16x16x32_bf16 v[20:23], v[224:227], v[100:103], v[20:23]
    s_setprio 0
    ds_read_b64_tr_b16 v[236:237], v194 offset:58368
    v_mfma_f32_16x16x32_bf16 v[24:27], v[224:227], v[104:107], v[24:27]
    v_mfma_f32_16x16x32_bf16 v[28:31], v[224:227], v[108:111], v[28:31]
    ds_read_b64_tr_b16 v[238:239], v194 offset:58880
    s_waitcnt lgkmcnt(4)
    v_mfma_f32_16x16x32_bf16 v[16:19], v[228:231], v[112:115], v[16:19]
    v_mfma_f32_16x16x32_bf16 v[20:23], v[228:231], v[116:119], v[20:23]
    s_waitcnt vmcnt(8) lgkmcnt(0)
    s_barrier
    s_setprio 3
    ds_read_b64_tr_b16 v[224:225], v194 offset:0
    v_mfma_f32_16x16x32_bf16 v[24:27], v[228:231], v[120:123], v[24:27]
    v_mfma_f32_16x16x32_bf16 v[28:31], v[228:231], v[124:127], v[28:31]
    s_add_u32 m0, s29, 49152
    s_sub_u32 s30, s30, 1179520
    ds_read_b64_tr_b16 v[226:227], v194 offset:512
    v_mfma_f32_16x16x32_bf16 v[16:19], v[232:235], v[128:131], v[16:19]
    buffer_load_dwordx4 v248, s[8:11], s30 offen lds
    v_mfma_f32_16x16x32_bf16 v[20:23], v[232:235], v[132:135], v[20:23]
    s_setprio 2
    ds_read_b64_tr_b16 v[228:229], v194 offset:8192
    v_mfma_f32_16x16x32_bf16 v[24:27], v[232:235], v[136:139], v[24:27]
    v_mfma_f32_16x16x32_bf16 v[28:31], v[232:235], v[140:143], v[28:31]
    ds_read_b64_tr_b16 v[230:231], v194 offset:8704
    v_mfma_f32_16x16x32_bf16 v[16:19], v[236:239], v[144:147], v[16:19]
    v_mfma_f32_16x16x32_bf16 v[20:23], v[236:239], v[148:151], v[20:23]
    s_setprio 1
    ds_read_b64_tr_b16 v[232:233], v194 offset:1024
    v_mfma_f32_16x16x32_bf16 v[24:27], v[236:239], v[152:155], v[24:27]
    v_mfma_f32_16x16x32_bf16 v[28:31], v[236:239], v[156:159], v[28:31]
    s_add_u32 m0, s29, 50176
    s_add_u32 s30, s30, 589824
    ds_read_b64_tr_b16 v[234:235], v194 offset:1536
    s_waitcnt lgkmcnt(4)
    v_mfma_f32_16x16x32_bf16 v[32:35], v[224:227], v[64:67], v[32:35]
    buffer_load_dwordx4 v248, s[8:11], s30 offen lds
    v_mfma_f32_16x16x32_bf16 v[36:39], v[224:227], v[68:71], v[36:39]
    s_setprio 0
    ds_read_b64_tr_b16 v[236:237], v194 offset:9216
    v_mfma_f32_16x16x32_bf16 v[40:43], v[224:227], v[72:75], v[40:43]
    v_mfma_f32_16x16x32_bf16 v[44:47], v[224:227], v[76:79], v[44:47]
    ds_read_b64_tr_b16 v[238:239], v194 offset:9728
    s_waitcnt lgkmcnt(4)
    v_mfma_f32_16x16x32_bf16 v[32:35], v[228:231], v[80:83], v[32:35]
    v_mfma_f32_16x16x32_bf16 v[36:39], v[228:231], v[84:87], v[36:39]
    s_waitcnt vmcnt(6) lgkmcnt(0)
    s_barrier
    s_setprio 3
    ds_read_b64_tr_b16 v[224:225], v194 offset:16384
    v_mfma_f32_16x16x32_bf16 v[40:43], v[228:231], v[88:91], v[40:43]
    v_mfma_f32_16x16x32_bf16 v[44:47], v[228:231], v[92:95], v[44:47]
    s_add_u32 m0, s29, 0
    s_add_u32 s30, s30, 589824
    ds_read_b64_tr_b16 v[226:227], v194 offset:16896
    v_mfma_f32_16x16x32_bf16 v[32:35], v[232:235], v[96:99], v[32:35]
    buffer_load_dwordx4 v248, s[8:11], s30 offen lds
    v_mfma_f32_16x16x32_bf16 v[36:39], v[232:235], v[100:103], v[36:39]
    s_setprio 2
    ds_read_b64_tr_b16 v[228:229], v194 offset:24576
    v_mfma_f32_16x16x32_bf16 v[40:43], v[232:235], v[104:107], v[40:43]
    v_mfma_f32_16x16x32_bf16 v[44:47], v[232:235], v[108:111], v[44:47]
    ds_read_b64_tr_b16 v[230:231], v194 offset:25088
    v_mfma_f32_16x16x32_bf16 v[32:35], v[236:239], v[112:115], v[32:35]
    v_mfma_f32_16x16x32_bf16 v[36:39], v[236:239], v[116:119], v[36:39]
    s_setprio 1
    ds_read_b64_tr_b16 v[232:233], v194 offset:17408
    v_mfma_f32_16x16x32_bf16 v[40:43], v[236:239], v[120:123], v[40:43]
    v_mfma_f32_16x16x32_bf16 v[44:47], v[236:239], v[124:127], v[44:47]
    s_add_u32 m0, s29, 1024
    s_sub_u32 s30, s30, 1179520
    ds_read_b64_tr_b16 v[234:235], v194 offset:17920
    s_waitcnt lgkmcnt(4)
    v_mfma_f32_16x16x32_bf16 v[32:35], v[224:227], v[128:131], v[32:35]
    buffer_load_dwordx4 v248, s[8:11], s30 offen lds
    v_mfma_f32_16x16x32_bf16 v[36:39], v[224:227], v[132:135], v[36:39]
    s_setprio 0
    ds_read_b64_tr_b16 v[236:237], v194 offset:25600
    v_mfma_f32_16x16x32_bf16 v[40:43], v[224:227], v[136:139], v[40:43]
    v_mfma_f32_16x16x32_bf16 v[44:47], v[224:227], v[140:143], v[44:47]
    ds_read_b64_tr_b16 v[238:239], v194 offset:26112
    s_waitcnt lgkmcnt(4)
    v_mfma_f32_16x16x32_bf16 v[32:35], v[228:231], v[144:147], v[32:35]
    v_mfma_f32_16x16x32_bf16 v[36:39], v[228:231], v[148:151], v[36:39]
    s_waitcnt vmcnt(4) lgkmcnt(0)
    s_barrier
    s_setprio 3
    ds_read_b64_tr_b16 v[224:225], v194 offset:32768
    v_mfma_f32_16x16x32_bf16 v[40:43], v[228:231], v[152:155], v[40:43]
    v_mfma_f32_16x16x32_bf16 v[44:47], v[228:231], v[156:159], v[44:47]
    s_add_u32 m0, s29, 16384
    s_add_u32 s30, s30, 589824
    ds_read_b64_tr_b16 v[226:227], v194 offset:33280
    v_mfma_f32_16x16x32_bf16 v[48:51], v[232:235], v[64:67], v[48:51]
    buffer_load_dwordx4 v248, s[8:11], s30 offen lds
    v_mfma_f32_16x16x32_bf16 v[52:55], v[232:235], v[68:71], v[52:55]
    s_setprio 2
    ds_read_b64_tr_b16 v[228:229], v194 offset:40960
    v_mfma_f32_16x16x32_bf16 v[56:59], v[232:235], v[72:75], v[56:59]
    v_mfma_f32_16x16x32_bf16 v[60:63], v[232:235], v[76:79], v[60:63]
    ds_read_b64_tr_b16 v[230:231], v194 offset:41472
    v_mfma_f32_16x16x32_bf16 v[48:51], v[236:239], v[80:83], v[48:51]
    v_mfma_f32_16x16x32_bf16 v[52:55], v[236:239], v[84:87], v[52:55]
    s_setprio 1
    ds_read_b64_tr_b16 v[232:233], v194 offset:33792
    v_mfma_f32_16x16x32_bf16 v[56:59], v[236:239], v[88:91], v[56:59]
    v_mfma_f32_16x16x32_bf16 v[60:63], v[236:239], v[92:95], v[60:63]
    s_add_u32 m0, s29, 17408
    s_add_u32 s30, s30, 589824
    ds_read_b64_tr_b16 v[234:235], v194 offset:34304
    s_waitcnt lgkmcnt(4)
    v_mfma_f32_16x16x32_bf16 v[48:51], v[224:227], v[96:99], v[48:51]
    buffer_load_dwordx4 v248, s[8:11], s30 offen lds
    v_mfma_f32_16x16x32_bf16 v[52:55], v[224:227], v[100:103], v[52:55]
    s_setprio 0
    ds_read_b64_tr_b16 v[236:237], v194 offset:41984
    v_mfma_f32_16x16x32_bf16 v[56:59], v[224:227], v[104:107], v[56:59]
    v_mfma_f32_16x16x32_bf16 v[60:63], v[224:227], v[108:111], v[60:63]
    ds_read_b64_tr_b16 v[238:239], v194 offset:42496
    s_waitcnt lgkmcnt(4)
    v_mfma_f32_16x16x32_bf16 v[48:51], v[228:231], v[112:115], v[48:51]
    v_mfma_f32_16x16x32_bf16 v[52:55], v[228:231], v[116:119], v[52:55]
    s_waitcnt vmcnt(4) lgkmcnt(0)
    s_barrier
    s_setprio 3
    ds_read_b64_tr_b16 v[224:225], v194 offset:49152
    v_mfma_f32_16x16x32_bf16 v[56:59], v[228:231], v[120:123], v[56:59]
    v_mfma_f32_16x16x32_bf16 v[60:63], v[228:231], v[124:127], v[60:63]
    s_add_u32 m0, s29, 32768
    s_add_u32 s30, s30, 589184
    ds_read_b64_tr_b16 v[226:227], v194 offset:49664
    v_mfma_f32_16x16x32_bf16 v[48:51], v[232:235], v[128:131], v[48:51]
    buffer_load_dwordx4 v248, s[8:11], s30 offen lds
    v_mfma_f32_16x16x32_bf16 v[52:55], v[232:235], v[132:135], v[52:55]
    s_setprio 2
    ds_read_b64_tr_b16 v[228:229], v194 offset:57344
    v_mfma_f32_16x16x32_bf16 v[56:59], v[232:235], v[136:139], v[56:59]
    v_mfma_f32_16x16x32_bf16 v[60:63], v[232:235], v[140:143], v[60:63]
    ds_read_b64_tr_b16 v[230:231], v194 offset:57856
    v_mfma_f32_16x16x32_bf16 v[48:51], v[236:239], v[144:147], v[48:51]
    v_mfma_f32_16x16x32_bf16 v[52:55], v[236:239], v[148:151], v[52:55]
    s_setprio 1
    ds_read_b64_tr_b16 v[232:233], v194 offset:50176
    v_mfma_f32_16x16x32_bf16 v[56:59], v[236:239], v[152:155], v[56:59]
    v_mfma_f32_16x16x32_bf16 v[60:63], v[236:239], v[156:159], v[60:63]
    s_add_u32 m0, s29, 33792
    s_add_u32 s30, s30, 589824
    ds_read_b64_tr_b16 v[234:235], v194 offset:50688
    s_waitcnt lgkmcnt(4)
    v_mfma_f32_16x16x32_bf16 v[160:163], v[224:227], v[64:67], v[160:163]
    buffer_load_dwordx4 v248, s[8:11], s30 offen lds
    v_mfma_f32_16x16x32_bf16 v[164:167], v[224:227], v[68:71], v[164:167]
    s_setprio 0
    ds_read_b64_tr_b16 v[236:237], v194 offset:58368
    v_mfma_f32_16x16x32_bf16 v[168:171], v[224:227], v[72:75], v[168:171]
    v_mfma_f32_16x16x32_bf16 v[172:175], v[224:227], v[76:79], v[172:175]
    ds_read_b64_tr_b16 v[238:239], v194 offset:58880
    s_waitcnt lgkmcnt(4)
    v_mfma_f32_16x16x32_bf16 v[160:163], v[228:231], v[80:83], v[160:163]
    v_mfma_f32_16x16x32_bf16 v[164:167], v[228:231], v[84:87], v[164:167]
    s_waitcnt vmcnt(4) lgkmcnt(0)
    s_barrier
    s_setprio 3
    ds_read_b64_tr_b16 v[224:225], v194 offset:0
    v_mfma_f32_16x16x32_bf16 v[168:171], v[228:231], v[88:91], v[168:171]
    v_mfma_f32_16x16x32_bf16 v[172:175], v[228:231], v[92:95], v[172:175]
    s_add_u32 m0, s29, 49152
    s_add_u32 s30, s30, 589824
    ds_read_b64_tr_b16 v[226:227], v194 offset:512
    v_mfma_f32_16x16x32_bf16 v[160:163], v[232:235], v[96:99], v[160:163]
    buffer_load_dwordx4 v248, s[8:11], s30 offen lds
    v_mfma_f32_16x16x32_bf16 v[164:167], v[232:235], v[100:103], v[164:167]
    s_setprio 2
    ds_read_b64_tr_b16 v[228:229], v194 offset:8192
    v_mfma_f32_16x16x32_bf16 v[168:171], v[232:235], v[104:107], v[168:171]
    v_mfma_f32_16x16x32_bf16 v[172:175], v[232:235], v[108:111], v[172:175]
    ds_read_b64_tr_b16 v[230:231], v194 offset:8704
    v_mfma_f32_16x16x32_bf16 v[160:163], v[236:239], v[112:115], v[160:163]
    v_mfma_f32_16x16x32_bf16 v[164:167], v[236:239], v[116:119], v[164:167]
    s_setprio 1
    ds_read_b64_tr_b16 v[232:233], v194 offset:1024
    v_mfma_f32_16x16x32_bf16 v[168:171], v[236:239], v[120:123], v[168:171]
    v_mfma_f32_16x16x32_bf16 v[172:175], v[236:239], v[124:127], v[172:175]
    s_add_u32 m0, s29, 50176
    s_sub_u32 s30, s30, 1179520
    ds_read_b64_tr_b16 v[234:235], v194 offset:1536
    s_waitcnt lgkmcnt(4)
    v_mfma_f32_16x16x32_bf16 v[160:163], v[224:227], v[128:131], v[160:163]
    buffer_load_dwordx4 v248, s[8:11], s30 offen lds
    v_mfma_f32_16x16x32_bf16 v[164:167], v[224:227], v[132:135], v[164:167]
    s_setprio 0
    ds_read_b64_tr_b16 v[236:237], v194 offset:9216
    v_mfma_f32_16x16x32_bf16 v[168:171], v[224:227], v[136:139], v[168:171]
    v_mfma_f32_16x16x32_bf16 v[172:175], v[224:227], v[140:143], v[172:175]
    ds_read_b64_tr_b16 v[238:239], v194 offset:9728
    s_waitcnt lgkmcnt(4)
    v_mfma_f32_16x16x32_bf16 v[160:163], v[228:231], v[144:147], v[160:163]
    v_mfma_f32_16x16x32_bf16 v[164:167], v[228:231], v[148:151], v[164:167]
    s_waitcnt vmcnt(4) lgkmcnt(0)
    s_barrier
    s_setprio 3
    ds_read_b64_tr_b16 v[224:225], v194 offset:16384
    v_mfma_f32_16x16x32_bf16 v[168:171], v[228:231], v[152:155], v[168:171]
    v_mfma_f32_16x16x32_bf16 v[172:175], v[228:231], v[156:159], v[172:175]
    s_add_u32 m0, s29, 0
    s_add_u32 s30, s30, 589824
    ds_read_b64_tr_b16 v[226:227], v194 offset:16896
    v_mfma_f32_16x16x32_bf16 v[176:179], v[232:235], v[64:67], v[176:179]
    buffer_load_dwordx4 v248, s[8:11], s30 offen lds
    v_mfma_f32_16x16x32_bf16 v[180:183], v[232:235], v[68:71], v[180:183]
    s_setprio 2
    ds_read_b64_tr_b16 v[228:229], v194 offset:24576
    v_mfma_f32_16x16x32_bf16 v[184:187], v[232:235], v[72:75], v[184:187]
    v_mfma_f32_16x16x32_bf16 v[188:191], v[232:235], v[76:79], v[188:191]
    ds_read_b64_tr_b16 v[230:231], v194 offset:25088
    v_subrev_u32 v192, 32768, v192
    v_subrev_u32 v193, 32768, v193
    ds_read_b128 v[64:67], v192 offset:0
    v_mfma_f32_16x16x32_bf16 v[176:179], v[236:239], v[80:83], v[176:179]
    ds_read_b128 v[68:71], v192 offset:2048
    v_mfma_f32_16x16x32_bf16 v[180:183], v[236:239], v[84:87], v[180:183]
    s_setprio 1
    ds_read_b64_tr_b16 v[232:233], v194 offset:17408
    ds_read_b128 v[72:75], v192 offset:4096
    v_mfma_f32_16x16x32_bf16 v[184:187], v[236:239], v[88:91], v[184:187]
    ds_read_b128 v[76:79], v192 offset:6144
    v_mfma_f32_16x16x32_bf16 v[188:191], v[236:239], v[92:95], v[188:191]
    s_add_u32 m0, s29, 1024
    s_add_u32 s30, s30, 589824
    ds_read_b64_tr_b16 v[234:235], v194 offset:17920
    buffer_load_dwordx4 v248, s[8:11], s30 offen lds
    s_waitcnt lgkmcnt(8)
    v_mfma_f32_16x16x32_bf16 v[176:179], v[224:227], v[96:99], v[176:179]
    ds_read_b128 v[80:83], v193 offset:0
    ds_read_b128 v[84:87], v193 offset:2048
    v_mfma_f32_16x16x32_bf16 v[180:183], v[224:227], v[100:103], v[180:183]
    s_setprio 0
    ds_read_b64_tr_b16 v[236:237], v194 offset:25600
    ds_read_b128 v[88:91], v193 offset:4096
    v_mfma_f32_16x16x32_bf16 v[184:187], v[224:227], v[104:107], v[184:187]
    ds_read_b128 v[92:95], v193 offset:6144
    v_mfma_f32_16x16x32_bf16 v[188:191], v[224:227], v[108:111], v[188:191]
    ds_read_b64_tr_b16 v[238:239], v194 offset:26112
    ds_read_b128 v[96:99], v192 offset:16384
    s_waitcnt lgkmcnt(13)
    v_mfma_f32_16x16x32_bf16 v[176:179], v[228:231], v[112:115], v[176:179]
    ds_read_b128 v[100:103], v192 offset:18432
    v_mfma_f32_16x16x32_bf16 v[180:183], v[228:231], v[116:119], v[180:183]
    s_waitcnt vmcnt(4) lgkmcnt(0)
    s_barrier
    s_setprio 3
    ds_read_b64_tr_b16 v[224:225], v194 offset:32768
    ds_read_b128 v[104:107], v192 offset:20480
    v_mfma_f32_16x16x32_bf16 v[184:187], v[228:231], v[120:123], v[184:187]
    ds_read_b128 v[108:111], v192 offset:22528
    v_mfma_f32_16x16x32_bf16 v[188:191], v[228:231], v[124:127], v[188:191]
    s_add_u32 m0, s29, 16384
    s_sub_u32 s30, s30, 1179520
    ds_read_b64_tr_b16 v[226:227], v194 offset:33280
    buffer_load_dwordx4 v248, s[8:11], s30 offen lds
    v_mfma_f32_16x16x32_bf16 v[176:179], v[232:235], v[128:131], v[176:179]
    ds_read_b128 v[112:115], v193 offset:16384
    ds_read_b128 v[116:119], v193 offset:18432
    v_mfma_f32_16x16x32_bf16 v[180:183], v[232:235], v[132:135], v[180:183]
    s_setprio 2
    ds_read_b64_tr_b16 v[228:229], v194 offset:40960
    ds_read_b128 v[120:123], v193 offset:20480
    v_mfma_f32_16x16x32_bf16 v[184:187], v[232:235], v[136:139], v[184:187]
    ds_read_b128 v[124:127], v193 offset:22528
    v_mfma_f32_16x16x32_bf16 v[188:191], v[232:235], v[140:143], v[188:191]
    ds_read_b64_tr_b16 v[230:231], v194 offset:41472
    ds_read_b128 v[128:131], v192 offset:32768
    v_mfma_f32_16x16x32_bf16 v[176:179], v[236:239], v[144:147], v[176:179]
    ds_read_b128 v[132:135], v192 offset:34816
    v_mfma_f32_16x16x32_bf16 v[180:183], v[236:239], v[148:151], v[180:183]
    s_setprio 1
    ds_read_b64_tr_b16 v[232:233], v194 offset:33792
    ds_read_b128 v[136:139], v192 offset:36864
    v_mfma_f32_16x16x32_bf16 v[184:187], v[236:239], v[152:155], v[184:187]
    ds_read_b128 v[140:143], v192 offset:38912
    v_mfma_f32_16x16x32_bf16 v[188:191], v[236:239], v[156:159], v[188:191]
    s_add_u32 m0, s29, 17408
    s_add_u32 s30, s30, 589824
    s_waitcnt lgkmcnt(13)
    ds_read_b64_tr_b16 v[234:235], v194 offset:34304
    buffer_load_dwordx4 v248, s[8:11], s30 offen lds
    s_waitcnt lgkmcnt(12)
    v_mfma_f32_16x16x32_bf16 v[0:3], v[224:227], v[64:67], v[0:3]
    ds_read_b128 v[144:147], v193 offset:32768
    ds_read_b128 v[148:151], v193 offset:34816
    v_mfma_f32_16x16x32_bf16 v[4:7], v[224:227], v[68:71], v[4:7]
    s_setprio 0
    ds_read_b64_tr_b16 v[236:237], v194 offset:41984
    s_waitcnt lgkmcnt(13)
    ds_read_b128 v[152:155], v193 offset:36864
    v_mfma_f32_16x16x32_bf16 v[8:11], v[224:227], v[72:75], v[8:11]
    ds_read_b128 v[156:159], v193 offset:38912
    v_mfma_f32_16x16x32_bf16 v[12:15], v[224:227], v[76:79], v[12:15]
    s_waitcnt lgkmcnt(13)
    ds_read_b64_tr_b16 v[238:239], v194 offset:42496
    s_waitcnt lgkmcnt(12)
    v_mfma_f32_16x16x32_bf16 v[0:3], v[228:231], v[80:83], v[0:3]
    v_mfma_f32_16x16x32_bf16 v[4:7], v[228:231], v[84:87], v[4:7]
    s_waitcnt vmcnt(4) lgkmcnt(0)
    s_barrier
    s_setprio 3
    ds_read_b64_tr_b16 v[224:225], v194 offset:49152
    v_mfma_f32_16x16x32_bf16 v[8:11], v[228:231], v[88:91], v[8:11]
    v_mfma_f32_16x16x32_bf16 v[12:15], v[228:231], v[92:95], v[12:15]
    s_add_u32 m0, s29, 32768
    s_add_u32 s30, s30, 589824
    ds_read_b64_tr_b16 v[226:227], v194 offset:49664
    v_mfma_f32_16x16x32_bf16 v[0:3], v[232:235], v[96:99], v[0:3]
    buffer_load_dwordx4 v248, s[8:11], s30 offen lds
    v_mfma_f32_16x16x32_bf16 v[4:7], v[232:235], v[100:103], v[4:7]
    s_setprio 2
    ds_read_b64_tr_b16 v[228:229], v194 offset:57344
    v_mfma_f32_16x16x32_bf16 v[8:11], v[232:235], v[104:107], v[8:11]
    v_mfma_f32_16x16x32_bf16 v[12:15], v[232:235], v[108:111], v[12:15]
    ds_read_b64_tr_b16 v[230:231], v194 offset:57856
    v_mfma_f32_16x16x32_bf16 v[0:3], v[236:239], v[112:115], v[0:3]
    v_mfma_f32_16x16x32_bf16 v[4:7], v[236:239], v[116:119], v[4:7]
    s_setprio 1
    ds_read_b64_tr_b16 v[232:233], v194 offset:50176
    v_mfma_f32_16x16x32_bf16 v[8:11], v[236:239], v[120:123], v[8:11]
    v_mfma_f32_16x16x32_bf16 v[12:15], v[236:239], v[124:127], v[12:15]
    s_add_u32 m0, s29, 33792
    s_sub_u32 s30, s30, 1179520
    ds_read_b64_tr_b16 v[234:235], v194 offset:50688
    s_waitcnt lgkmcnt(4)
    v_mfma_f32_16x16x32_bf16 v[0:3], v[224:227], v[128:131], v[0:3]
    buffer_load_dwordx4 v248, s[8:11], s30 offen lds
    v_mfma_f32_16x16x32_bf16 v[4:7], v[224:227], v[132:135], v[4:7]
    s_setprio 0
    ds_read_b64_tr_b16 v[236:237], v194 offset:58368
    v_mfma_f32_16x16x32_bf16 v[8:11], v[224:227], v[136:139], v[8:11]
    v_mfma_f32_16x16x32_bf16 v[12:15], v[224:227], v[140:143], v[12:15]
    ds_read_b64_tr_b16 v[238:239], v194 offset:58880
    s_waitcnt lgkmcnt(4)
    v_mfma_f32_16x16x32_bf16 v[0:3], v[228:231], v[144:147], v[0:3]
    v_mfma_f32_16x16x32_bf16 v[4:7], v[228:231], v[148:151], v[4:7]
    s_waitcnt vmcnt(4) lgkmcnt(0)
    s_barrier
    s_setprio 3
    ds_read_b64_tr_b16 v[224:225], v194 offset:0
    v_mfma_f32_16x16x32_bf16 v[8:11], v[228:231], v[152:155], v[8:11]
    v_mfma_f32_16x16x32_bf16 v[12:15], v[228:231], v[156:159], v[12:15]
    s_add_u32 m0, s29, 49152
    s_add_u32 s30, s30, 589824
    ds_read_b64_tr_b16 v[226:227], v194 offset:512
    v_mfma_f32_16x16x32_bf16 v[16:19], v[232:235], v[64:67], v[16:19]
    buffer_load_dwordx4 v248, s[8:11], s30 offen lds
    v_mfma_f32_16x16x32_bf16 v[20:23], v[232:235], v[68:71], v[20:23]
    s_setprio 2
    ds_read_b64_tr_b16 v[228:229], v194 offset:8192
    v_mfma_f32_16x16x32_bf16 v[24:27], v[232:235], v[72:75], v[24:27]
    v_mfma_f32_16x16x32_bf16 v[28:31], v[232:235], v[76:79], v[28:31]
    ds_read_b64_tr_b16 v[230:231], v194 offset:8704
    v_mfma_f32_16x16x32_bf16 v[16:19], v[236:239], v[80:83], v[16:19]
    v_mfma_f32_16x16x32_bf16 v[20:23], v[236:239], v[84:87], v[20:23]
    s_setprio 1
    ds_read_b64_tr_b16 v[232:233], v194 offset:1024
    v_fma_f32 v244, v0, s56, -0.5
    v_fma_f32 v245, v1, s56, -0.5
    v_fma_f32 v246, v2, s56, -0.5
    v_fma_f32 v247, v3, s56, -0.5
    v_exp_f32 v244, v244
    v_exp_f32 v245, v245
    v_mfma_f32_16x16x32_bf16 v[24:27], v[236:239], v[88:91], v[24:27]
    v_exp_f32 v246, v246
    v_exp_f32 v247, v247
    v_add_f32 v244, s57, v244
    v_add_f32 v245, s57, v245
    v_mfma_f32_16x16x32_bf16 v[28:31], v[236:239], v[92:95], v[28:31]
    s_add_u32 m0, s29, 50176
    s_add_u32 s30, s30, 589824
    ds_read_b64_tr_b16 v[234:235], v194 offset:1536
    buffer_load_dwordx4 v248, s[8:11], s30 offen lds
    s_waitcnt lgkmcnt(4)
    v_mfma_f32_16x16x32_bf16 v[16:19], v[224:227], v[96:99], v[16:19]
    v_add_f32 v246, s57, v246
    v_add_f32 v247, s57, v247
    v_fma_f32 v244, -v244, v244, -0.5
    v_fma_f32 v245, -v245, v245, -0.5
    v_fma_f32 v246, -v246, v246, -0.5
    v_mfma_f32_16x16x32_bf16 v[20:23], v[224:227], v[100:103], v[20:23]
    s_setprio 0
    ds_read_b64_tr_b16 v[236:237], v194 offset:9216
    v_fma_f32 v247, -v247, v247, -0.5
    v_rcp_f32 v244, v244
    v_rcp_f32 v245, v245
    v_rcp_f32 v246, v246
    v_mfma_f32_16x16x32_bf16 v[24:27], v[224:227], v[104:107], v[24:27]
    v_rcp_f32 v247, v247
    v_fmac_f32 v0, v244, v0
    v_fmac_f32 v1, v245, v1
    v_fmac_f32 v2, v246, v2
    v_fmac_f32 v3, v247, v3
    v_cvt_pk_bf16_f32 v0, v0, v1
    v_mfma_f32_16x16x32_bf16 v[28:31], v[224:227], v[108:111], v[28:31]
    ds_read_b64_tr_b16 v[238:239], v194 offset:9728
    v_cvt_pk_bf16_f32 v1, v2, v3
    ds_write_b64 v255, v[0:1] offset:0
    v_fma_f32 v244, v4, s56, -0.5
    v_fma_f32 v245, v5, s56, -0.5
    v_fma_f32 v246, v6, s56, -0.5
    s_waitcnt lgkmcnt(5)
    v_mfma_f32_16x16x32_bf16 v[16:19], v[228:231], v[112:115], v[16:19]
    v_fma_f32 v247, v7, s56, -0.5
    v_exp_f32 v244, v244
    v_exp_f32 v245, v245
    v_exp_f32 v246, v246
    v_mfma_f32_16x16x32_bf16 v[20:23], v[228:231], v[116:119], v[20:23]
    s_waitcnt vmcnt(4) lgkmcnt(0)
    s_barrier
    s_setprio 3
    ds_read_b64_tr_b16 v[224:225], v194 offset:16384
    v_exp_f32 v247, v247
    v_add_f32 v244, s57, v244
    v_add_f32 v245, s57, v245
    v_add_f32 v246, s57, v246
    v_add_f32 v247, s57, v247
    v_fma_f32 v244, -v244, v244, -0.5
    v_fma_f32 v245, -v245, v245, -0.5
    v_mfma_f32_16x16x32_bf16 v[24:27], v[228:231], v[120:123], v[24:27]
    v_fma_f32 v246, -v246, v246, -0.5
    v_fma_f32 v247, -v247, v247, -0.5
    v_rcp_f32 v244, v244
    v_rcp_f32 v245, v245
    v_mfma_f32_16x16x32_bf16 v[28:31], v[228:231], v[124:127], v[28:31]
    s_add_u32 m0, s29, 0
    s_sub_u32 s30, s30, 1179520
    ds_read_b64_tr_b16 v[226:227], v194 offset:16896
    buffer_load_dwordx4 v248, s[8:11], s30 offen lds
    v_mfma_f32_16x16x32_bf16 v[16:19], v[232:235], v[128:131], v[16:19]
    v_rcp_f32 v246, v246
    v_rcp_f32 v247, v247
    v_fmac_f32 v4, v244, v4
    v_mfma_f32_16x16x32_bf16 v[20:23], v[232:235], v[132:135], v[20:23]
    s_setprio 2
    ds_read_b64_tr_b16 v[228:229], v194 offset:24576
    v_fmac_f32 v5, v245, v5
    v_fmac_f32 v6, v246, v6
    v_fmac_f32 v7, v247, v7
    v_cvt_pk_bf16_f32 v2, v4, v5
    v_cvt_pk_bf16_f32 v3, v6, v7
    ds_write_b64 v255, v[2:3] offset:1024
    v_mfma_f32_16x16x32_bf16 v[24:27], v[232:235], v[136:139], v[24:27]
    v_fma_f32 v244, v8, s56, -0.5
    v_fma_f32 v245, v9, s56, -0.5
    v_fma_f32 v246, v10, s56, -0.5
    v_fma_f32 v247, v11, s56, -0.5
    v_mfma_f32_16x16x32_bf16 v[28:31], v[232:235], v[140:143], v[28:31]
    ds_read_b64_tr_b16 v[230:231], v194 offset:25088
    v_exp_f32 v244, v244
    v_exp_f32 v245, v245
    v_exp_f32 v246, v246
    v_exp_f32 v247, v247
    v_mfma_f32_16x16x32_bf16 v[16:19], v[236:239], v[144:147], v[16:19]
    v_add_f32 v244, s57, v244
    v_add_f32 v245, s57, v245
    v_add_f32 v246, s57, v246
    v_add_f32 v247, s57, v247
    v_fma_f32 v244, -v244, v244, -0.5
    v_fma_f32 v245, -v245, v245, -0.5
    v_mfma_f32_16x16x32_bf16 v[20:23], v[236:239], v[148:151], v[20:23]
    s_setprio 1
    ds_read_b64_tr_b16 v[232:233], v194 offset:17408
    v_fma_f32 v246, -v246, v246, -0.5
    v_fma_f32 v247, -v247, v247, -0.5
    v_rcp_f32 v244, v244
    v_rcp_f32 v245, v245
    v_rcp_f32 v246, v246
    v_mfma_f32_16x16x32_bf16 v[24:27], v[236:239], v[152:155], v[24:27]
    v_rcp_f32 v247, v247
    v_fmac_f32 v8, v244, v8
    v_fmac_f32 v9, v245, v9
    v_fmac_f32 v10, v246, v10
    v_fmac_f32 v11, v247, v11
    v_mfma_f32_16x16x32_bf16 v[28:31], v[236:239], v[156:159], v[28:31]
    s_add_u32 m0, s29, 1024
    s_add_u32 s30, s30, 589824
    ds_read_b64_tr_b16 v[234:235], v194 offset:17920
    buffer_load_dwordx4 v248, s[8:11], s30 offen lds
    s_waitcnt lgkmcnt(5)
    v_mfma_f32_16x16x32_bf16 v[32:35], v[224:227], v[64:67], v[32:35]
    v_cvt_pk_bf16_f32 v4, v8, v9
    v_cvt_pk_bf16_f32 v5, v10, v11
    ds_write_b64 v255, v[4:5] offset:4096
    v_mfma_f32_16x16x32_bf16 v[36:39], v[224:227], v[68:71], v[36:39]
    s_setprio 0
    ds_read_b64_tr_b16 v[236:237], v194 offset:25600
    v_fma_f32 v244, v12, s56, -0.5
    v_fma_f32 v245, v13, s56, -0.5
    v_fma_f32 v246, v14, s56, -0.5
    v_fma_f32 v247, v15, s56, -0.5
    v_exp_f32 v244, v244
    v_exp_f32 v245, v245
    v_mfma_f32_16x16x32_bf16 v[40:43], v[224:227], v[72:75], v[40:43]
    v_exp_f32 v246, v246
    v_exp_f32 v247, v247
    v_add_f32 v244, s57, v244
    v_add_f32 v245, s57, v245
    v_mfma_f32_16x16x32_bf16 v[44:47], v[224:227], v[76:79], v[44:47]
    ds_read_b64_tr_b16 v[238:239], v194 offset:26112
    v_add_f32 v246, s57, v246
    v_add_f32 v247, s57, v247
    v_fma_f32 v244, -v244, v244, -0.5
    v_fma_f32 v245, -v245, v245, -0.5
    v_fma_f32 v246, -v246, v246, -0.5
    v_fma_f32 v247, -v247, v247, -0.5
    v_rcp_f32 v244, v244
    s_waitcnt lgkmcnt(5)
    v_mfma_f32_16x16x32_bf16 v[32:35], v[228:231], v[80:83], v[32:35]
    v_rcp_f32 v245, v245
    v_rcp_f32 v246, v246
    v_rcp_f32 v247, v247
    v_mfma_f32_16x16x32_bf16 v[36:39], v[228:231], v[84:87], v[36:39]
    s_waitcnt vmcnt(4) lgkmcnt(0)
    s_barrier
    s_setprio 3
    ds_read_b64_tr_b16 v[224:225], v194 offset:32768
    v_fmac_f32 v12, v244, v12
    v_fmac_f32 v13, v245, v13
    v_fmac_f32 v14, v246, v14
    v_fmac_f32 v15, v247, v15
    v_cvt_pk_bf16_f32 v6, v12, v13
    v_mfma_f32_16x16x32_bf16 v[40:43], v[228:231], v[88:91], v[40:43]
    v_cvt_pk_bf16_f32 v7, v14, v15
    ds_write_b64 v255, v[6:7] offset:5120
    v_add_u32 v255, 16384, v255
    v_mfma_f32_16x16x32_bf16 v[44:47], v[228:231], v[92:95], v[44:47]
    s_add_u32 m0, s29, 16384
    s_add_u32 s30, s30, 589824
    ds_read_b64_tr_b16 v[226:227], v194 offset:33280
    buffer_load_dwordx4 v248, s[8:11], s30 offen lds
    v_mfma_f32_16x16x32_bf16 v[32:35], v[232:235], v[96:99], v[32:35]
    v_fma_f32 v244, v16, s56, -0.5
    v_fma_f32 v245, v17, s56, -0.5
    v_fma_f32 v246, v18, s56, -0.5
    v_fma_f32 v247, v19, s56, -0.5
    v_exp_f32 v244, v244
    v_mfma_f32_16x16x32_bf16 v[36:39], v[232:235], v[100:103], v[36:39]
    s_setprio 2
    ds_read_b64_tr_b16 v[228:229], v194 offset:40960
    v_exp_f32 v245, v245
    v_exp_f32 v246, v246
    v_exp_f32 v247, v247
    v_add_f32 v244, s57, v244
    v_add_f32 v245, s57, v245
    v_mfma_f32_16x16x32_bf16 v[40:43], v[232:235], v[104:107], v[40:43]
    v_add_f32 v246, s57, v246
    v_add_f32 v247, s57, v247
    v_fma_f32 v244, -v244, v244, -0.5
    v_fma_f32 v245, -v245, v245, -0.5
    v_fma_f32 v246, -v246, v246, -0.5
    v_fma_f32 v247, -v247, v247, -0.5
    v_mfma_f32_16x16x32_bf16 v[44:47], v[232:235], v[108:111], v[44:47]
    ds_read_b64_tr_b16 v[230:231], v194 offset:41472
    v_rcp_f32 v244, v244
    v_rcp_f32 v245, v245
    v_rcp_f32 v246, v246
    v_rcp_f32 v247, v247
    v_mfma_f32_16x16x32_bf16 v[32:35], v[236:239], v[112:115], v[32:35]
    v_fmac_f32 v16, v244, v16
    v_fmac_f32 v17, v245, v17
    v_fmac_f32 v18, v246, v18
    v_fmac_f32 v19, v247, v19
    v_cvt_pk_bf16_f32 v16, v16, v17
    v_cvt_pk_bf16_f32 v17, v18, v19
    v_mfma_f32_16x16x32_bf16 v[36:39], v[236:239], v[116:119], v[36:39]
    s_setprio 1
    ds_read_b64_tr_b16 v[232:233], v194 offset:33792
    ds_write_b64 v255, v[16:17] offset:0
    v_fma_f32 v244, v20, s56, -0.5
    v_fma_f32 v245, v21, s56, -0.5
    v_fma_f32 v246, v22, s56, -0.5
    v_fma_f32 v247, v23, s56, -0.5
    v_mfma_f32_16x16x32_bf16 v[40:43], v[236:239], v[120:123], v[40:43]
    v_exp_f32 v244, v244
    v_exp_f32 v245, v245
    v_exp_f32 v246, v246
    v_mfma_f32_16x16x32_bf16 v[44:47], v[236:239], v[124:127], v[44:47]
    s_add_u32 m0, s29, 17408
    s_sub_u32 s30, s30, 1179520
    ds_read_b64_tr_b16 v[234:235], v194 offset:34304
    buffer_load_dwordx4 v248, s[8:11], s30 offen lds
    s_waitcnt lgkmcnt(5)
    v_mfma_f32_16x16x32_bf16 v[32:35], v[224:227], v[128:131], v[32:35]
    v_exp_f32 v247, v247
    v_add_f32 v244, s57, v244
    v_add_f32 v245, s57, v245
    v_add_f32 v246, s57, v246
    v_add_f32 v247, s57, v247
    v_mfma_f32_16x16x32_bf16 v[36:39], v[224:227], v[132:135], v[36:39]
    s_setprio 0
    ds_read_b64_tr_b16 v[236:237], v194 offset:41984
    v_fma_f32 v244, -v244, v244, -0.5
    v_fma_f32 v245, -v245, v245, -0.5
    v_fma_f32 v246, -v246, v246, -0.5
    v_fma_f32 v247, -v247, v247, -0.5
    v_rcp_f32 v244, v244
    v_rcp_f32 v245, v245
    v_mfma_f32_16x16x32_bf16 v[40:43], v[224:227], v[136:139], v[40:43]
    v_rcp_f32 v246, v246
    v_rcp_f32 v247, v247
    v_fmac_f32 v20, v244, v20
    v_fmac_f32 v21, v245, v21
    v_fmac_f32 v22, v246, v22
    v_mfma_f32_16x16x32_bf16 v[44:47], v[224:227], v[140:143], v[44:47]
    ds_read_b64_tr_b16 v[238:239], v194 offset:42496
    v_fmac_f32 v23, v247, v23
    v_cvt_pk_bf16_f32 v18, v20, v21
    v_cvt_pk_bf16_f32 v19, v22, v23
    ds_write_b64 v255, v[18:19] offset:1024
    v_fma_f32 v244, v24, s56, -0.5
    v_fma_f32 v245, v25, s56, -0.5
    s_waitcnt lgkmcnt(6)
    v_mfma_f32_16x16x32_bf16 v[32:35], v[228:231], v[144:147], v[32:35]
    v_fma_f32 v246, v26, s56, -0.5
    v_fma_f32 v247, v27, s56, -0.5
    v_exp_f32 v244, v244
    v_exp_f32 v245, v245
    v_mfma_f32_16x16x32_bf16 v[36:39], v[228:231], v[148:151], v[36:39]
    s_waitcnt vmcnt(4) lgkmcnt(0)
    s_barrier
    global_load_dword v200, v201, s[54:55] sc1
    s_setprio 3
    ds_read_b64_tr_b16 v[224:225], v194 offset:49152
    v_exp_f32 v246, v246
    v_exp_f32 v247, v247
    v_add_f32 v244, s57, v244
    v_add_f32 v245, s57, v245
    v_add_f32 v246, s57, v246
    v_add_f32 v247, s57, v247
    v_mfma_f32_16x16x32_bf16 v[40:43], v[228:231], v[152:155], v[40:43]
    v_fma_f32 v244, -v244, v244, -0.5
    v_fma_f32 v245, -v245, v245, -0.5
    v_fma_f32 v246, -v246, v246, -0.5
    v_fma_f32 v247, -v247, v247, -0.5
    v_rcp_f32 v244, v244
    v_mfma_f32_16x16x32_bf16 v[44:47], v[228:231], v[156:159], v[44:47]
    s_add_u32 m0, s29, 32768
    s_add_u32 s30, s30, 589824
    ds_read_b64_tr_b16 v[226:227], v194 offset:49664
    buffer_load_dwordx4 v248, s[8:11], s30 offen lds
    v_mfma_f32_16x16x32_bf16 v[48:51], v[232:235], v[64:67], v[48:51]
    v_rcp_f32 v245, v245
    v_rcp_f32 v246, v246
    v_rcp_f32 v247, v247
    v_mfma_f32_16x16x32_bf16 v[52:55], v[232:235], v[68:71], v[52:55]
    s_setprio 2
    ds_read_b64_tr_b16 v[228:229], v194 offset:57344
    v_fmac_f32 v24, v244, v24
    v_fmac_f32 v25, v245, v25
    v_fmac_f32 v26, v246, v26
    v_fmac_f32 v27, v247, v27
    v_cvt_pk_bf16_f32 v20, v24, v25
    v_cvt_pk_bf16_f32 v21, v26, v27
    v_mfma_f32_16x16x32_bf16 v[56:59], v[232:235], v[72:75], v[56:59]
    ds_write_b64 v255, v[20:21] offset:4096
    v_fma_f32 v244, v28, s56, -0.5
    v_fma_f32 v245, v29, s56, -0.5
    v_fma_f32 v246, v30, s56, -0.5
    v_fma_f32 v247, v31, s56, -0.5
    v_mfma_f32_16x16x32_bf16 v[60:63], v[232:235], v[76:79], v[60:63]
    ds_read_b64_tr_b16 v[230:231], v194 offset:57856
    v_exp_f32 v244, v244
    v_exp_f32 v245, v245
    v_exp_f32 v246, v246
    v_exp_f32 v247, v247
    v_mfma_f32_16x16x32_bf16 v[48:51], v[236:239], v[80:83], v[48:51]
    v_add_f32 v244, s57, v244
    v_add_f32 v245, s57, v245
    v_add_f32 v246, s57, v246
    v_add_f32 v247, s57, v247
    v_fma_f32 v244, -v244, v244, -0.5
    v_fma_f32 v245, -v245, v245, -0.5
    v_fma_f32 v246, -v246, v246, -0.5
    v_mfma_f32_16x16x32_bf16 v[52:55], v[236:239], v[84:87], v[52:55]
    s_setprio 1
    ds_read_b64_tr_b16 v[232:233], v194 offset:50176
    v_fma_f32 v247, -v247, v247, -0.5
    v_rcp_f32 v244, v244
    v_rcp_f32 v245, v245
    v_rcp_f32 v246, v246
    v_rcp_f32 v247, v247
    v_mfma_f32_16x16x32_bf16 v[56:59], v[236:239], v[88:91], v[56:59]
    v_fmac_f32 v28, v244, v28
    v_fmac_f32 v29, v245, v29
    v_fmac_f32 v30, v246, v30
    v_fmac_f32 v31, v247, v31
    v_cvt_pk_bf16_f32 v22, v28, v29
    v_cvt_pk_bf16_f32 v23, v30, v31
    v_mfma_f32_16x16x32_bf16 v[60:63], v[236:239], v[92:95], v[60:63]
    s_add_u32 m0, s29, 33792
    s_add_u32 s30, s30, 589824
    ds_read_b64_tr_b16 v[234:235], v194 offset:50688
    buffer_load_dwordx4 v248, s[8:11], s30 offen lds
    s_waitcnt lgkmcnt(5)
    v_mfma_f32_16x16x32_bf16 v[48:51], v[224:227], v[96:99], v[48:51]
    ds_write_b64 v255, v[22:23] offset:5120
    v_add_u32 v255, 16384, v255
    v_mfma_f32_16x16x32_bf16 v[52:55], v[224:227], v[100:103], v[52:55]
    s_setprio 0
    ds_read_b64_tr_b16 v[236:237], v194 offset:58368
    v_fma_f32 v244, v32, s56, -0.5
    v_fma_f32 v245, v33, s56, -0.5
    v_fma_f32 v246, v34, s56, -0.5
    v_fma_f32 v247, v35, s56, -0.5
    v_exp_f32 v244, v244
    v_exp_f32 v245, v245
    v_mfma_f32_16x16x32_bf16 v[56:59], v[224:227], v[104:107], v[56:59]
    v_exp_f32 v246, v246
    v_exp_f32 v247, v247
    v_add_f32 v244, s57, v244
    v_add_f32 v245, s57, v245
    v_mfma_f32_16x16x32_bf16 v[60:63], v[224:227], v[108:111], v[60:63]
    ds_read_b64_tr_b16 v[238:239], v194 offset:58880
    v_add_f32 v246, s57, v246
    v_add_f32 v247, s57, v247
    v_fma_f32 v244, -v244, v244, -0.5
    v_fma_f32 v245, -v245, v245, -0.5
    v_fma_f32 v246, -v246, v246, -0.5
    v_fma_f32 v247, -v247, v247, -0.5
    v_rcp_f32 v244, v244
    s_waitcnt lgkmcnt(5)
    v_mfma_f32_16x16x32_bf16 v[48:51], v[228:231], v[112:115], v[48:51]
    v_rcp_f32 v245, v245
    v_rcp_f32 v246, v246
    v_rcp_f32 v247, v247
    v_mfma_f32_16x16x32_bf16 v[52:55], v[228:231], v[116:119], v[52:55]
    s_waitcnt vmcnt(5) lgkmcnt(0)
    s_barrier
    s_setprio 3
    ds_read_b64_tr_b16 v[224:225], v194 offset:0
    v_fmac_f32 v32, v244, v32
    v_fmac_f32 v33, v245, v33
    v_fmac_f32 v34, v246, v34
    v_fmac_f32 v35, v247, v35
    v_cvt_pk_bf16_f32 v32, v32, v33
    v_cvt_pk_bf16_f32 v33, v34, v35
    v_mfma_f32_16x16x32_bf16 v[56:59], v[228:231], v[120:123], v[56:59]
    ds_write_b64 v255, v[32:33] offset:0
    v_fma_f32 v244, v36, s56, -0.5
    v_fma_f32 v245, v37, s56, -0.5
    v_fma_f32 v246, v38, s56, -0.5
    v_fma_f32 v247, v39, s56, -0.5
    v_mfma_f32_16x16x32_bf16 v[60:63], v[228:231], v[124:127], v[60:63]
    s_add_u32 m0, s29, 49152
    v_mov_b32 v248, v196
    ds_read_b64_tr_b16 v[226:227], v194 offset:512
    buffer_load_dwordx4 v248, s[12:15], s31 offen lds
    v_mfma_f32_16x16x32_bf16 v[48:51], v[232:235], v[128:131], v[48:51]
    v_exp_f32 v244, v244
    v_exp_f32 v245, v245
    v_mfma_f32_16x16x32_bf16 v[52:55], v[232:235], v[132:135], v[52:55]
    s_setprio 2
    ds_read_b64_tr_b16 v[228:229], v194 offset:8192
    v_exp_f32 v246, v246
    v_exp_f32 v247, v247
    v_add_f32 v244, s57, v244
    v_add_f32 v245, s57, v245
    v_add_f32 v246, s57, v246
    v_add_f32 v247, s57, v247
    v_mfma_f32_16x16x32_bf16 v[56:59], v[232:235], v[136:139], v[56:59]
    v_fma_f32 v244, -v244, v244, -0.5
    v_fma_f32 v245, -v245, v245, -0.5
    v_fma_f32 v246, -v246, v246, -0.5
    v_fma_f32 v247, -v247, v247, -0.5
    v_rcp_f32 v244, v244
    v_mfma_f32_16x16x32_bf16 v[60:63], v[232:235], v[140:143], v[60:63]
    ds_read_b64_tr_b16 v[230:231], v194 offset:8704
    v_rcp_f32 v245, v245
    v_rcp_f32 v246, v246
    v_rcp_f32 v247, v247
    v_fmac_f32 v36, v244, v36
    v_mfma_f32_16x16x32_bf16 v[48:51], v[236:239], v[144:147], v[48:51]
    v_fmac_f32 v37, v245, v37
    v_fmac_f32 v38, v246, v38
    v_fmac_f32 v39, v247, v39
    v_cvt_pk_bf16_f32 v34, v36, v37
    v_cvt_pk_bf16_f32 v35, v38, v39
    v_mfma_f32_16x16x32_bf16 v[52:55], v[236:239], v[148:151], v[52:55]
    s_setprio 1
    ds_read_b64_tr_b16 v[232:233], v194 offset:1024
    ds_write_b64 v255, v[34:35] offset:1024
    v_fma_f32 v244, v40, s56, -0.5
    v_fma_f32 v245, v41, s56, -0.5
    v_fma_f32 v246, v42, s56, -0.5
    v_fma_f32 v247, v43, s56, -0.5
    v_mfma_f32_16x16x32_bf16 v[56:59], v[236:239], v[152:155], v[56:59]
    v_exp_f32 v244, v244
    v_exp_f32 v245, v245
    v_exp_f32 v246, v246
    v_mfma_f32_16x16x32_bf16 v[60:63], v[236:239], v[156:159], v[60:63]
    s_add_u32 m0, s29, 50176
    s_add_u32 s31, s31, 73728
    ds_read_b64_tr_b16 v[234:235], v194 offset:1536
    buffer_load_dwordx4 v248, s[12:15], s31 offen lds
    s_waitcnt lgkmcnt(5)
    v_mfma_f32_16x16x32_bf16 v[160:163], v[224:227], v[64:67], v[160:163]
    v_exp_f32 v247, v247
    v_add_f32 v244, s57, v244
    v_add_f32 v245, s57, v245
    v_add_f32 v246, s57, v246
    v_mfma_f32_16x16x32_bf16 v[164:167], v[224:227], v[68:71], v[164:167]
    s_setprio 0
    ds_read_b64_tr_b16 v[236:237], v194 offset:9216
    v_add_f32 v247, s57, v247
    v_fma_f32 v244, -v244, v244, -0.5
    v_fma_f32 v245, -v245, v245, -0.5
    v_fma_f32 v246, -v246, v246, -0.5
    v_fma_f32 v247, -v247, v247, -0.5
    v_rcp_f32 v244, v244
    v_rcp_f32 v245, v245
    v_mfma_f32_16x16x32_bf16 v[168:171], v[224:227], v[72:75], v[168:171]
    v_rcp_f32 v246, v246
    v_rcp_f32 v247, v247
    v_fmac_f32 v40, v244, v40
    ds_read_b128 v[0:3], v250 offset:0
    v_mfma_f32_16x16x32_bf16 v[172:175], v[224:227], v[76:79], v[172:175]
    ds_read_b64_tr_b16 v[238:239], v194 offset:9728
    v_fmac_f32 v41, v245, v41
    v_fmac_f32 v42, v246, v42
    v_fmac_f32 v43, v247, v43
    v_cvt_pk_bf16_f32 v36, v40, v41
    v_cvt_pk_bf16_f32 v37, v42, v43
    ds_write_b64 v255, v[36:37] offset:4096
    s_waitcnt lgkmcnt(7)
    v_mfma_f32_16x16x32_bf16 v[160:163], v[228:231], v[80:83], v[160:163]
    v_fma_f32 v244, v44, s56, -0.5
    v_fma_f32 v245, v45, s56, -0.5
    v_fma_f32 v246, v46, s56, -0.5
    v_fma_f32 v247, v47, s56, -0.5
    v_exp_f32 v244, v244
    v_mfma_f32_16x16x32_bf16 v[164:167], v[228:231], v[84:87], v[164:167]
    s_waitcnt vmcnt(5) lgkmcnt(0)
    s_barrier
    s_setprio 3
    ds_read_b64_tr_b16 v[224:225], v194 offset:16384
    v_exp_f32 v245, v245
    v_exp_f32 v246, v246
    v_exp_f32 v247, v247
    v_add_f32 v244, s57, v244
    v_add_f32 v245, s57, v245
    v_add_f32 v246, s57, v246
    v_mfma_f32_16x16x32_bf16 v[168:171], v[228:231], v[88:91], v[168:171]
    v_add_f32 v247, s57, v247
    v_fma_f32 v244, -v244, v244, -0.5
    v_fma_f32 v245, -v245, v245, -0.5
    v_fma_f32 v246, -v246, v246, -0.5
    v_fma_f32 v247, -v247, v247, -0.5
    ds_read_b128 v[16:19], v250 offset:2048
    v_mfma_f32_16x16x32_bf16 v[172:175], v[228:231], v[92:95], v[172:175]
    s_add_u32 m0, s29, 0
    s_add_u32 s31, s31, 73728
    ds_read_b64_tr_b16 v[226:227], v194 offset:16896
    buffer_load_dwordx4 v248, s[12:15], s31 offen lds
    v_mfma_f32_16x16x32_bf16 v[160:163], v[232:235], v[96:99], v[160:163]
    v_rcp_f32 v244, v244
    v_rcp_f32 v245, v245
    ds_read_b128 v[4:7], v250 offset:1024
    v_mfma_f32_16x16x32_bf16 v[164:167], v[232:235], v[100:103], v[164:167]
    s_setprio 2
    ds_read_b64_tr_b16 v[228:229], v194 offset:24576
    v_rcp_f32 v246, v246
    v_rcp_f32 v247, v247
    v_fmac_f32 v44, v244, v44
    v_fmac_f32 v45, v245, v45
    v_fmac_f32 v46, v246, v46
    v_fmac_f32 v47, v247, v47
    v_mfma_f32_16x16x32_bf16 v[168:171], v[232:235], v[104:107], v[168:171]
    v_cvt_pk_bf16_f32 v38, v44, v45
    v_cvt_pk_bf16_f32 v39, v46, v47
    ds_write_b64 v255, v[38:39] offset:5120
    v_add_u32 v255, 16384, v255
    v_mfma_f32_16x16x32_bf16 v[172:175], v[232:235], v[108:111], v[172:175]
    ds_read_b64_tr_b16 v[230:231], v194 offset:25088
    v_fma_f32 v244, v48, s56, -0.5
    v_fma_f32 v245, v49, s56, -0.5
    v_fma_f32 v246, v50, s56, -0.5
    v_fma_f32 v247, v51, s56, -0.5
    v_exp_f32 v244, v244
    v_exp_f32 v245, v245
    v_mfma_f32_16x16x32_bf16 v[160:163], v[236:239], v[112:115], v[160:163]
    v_exp_f32 v246, v246
    v_exp_f32 v247, v247
    v_add_f32 v244, s57, v244
    v_add_f32 v245, s57, v245
    ds_read_b128 v[8:11], v250 offset:4096
    v_mfma_f32_16x16x32_bf16 v[164:167], v[236:239], v[116:119], v[164:167]
    s_setprio 1
    ds_read_b64_tr_b16 v[232:233], v194 offset:17408
    v_add_f32 v246, s57, v246
    v_add_f32 v247, s57, v247
    v_fma_f32 v244, -v244, v244, -0.5
    v_fma_f32 v245, -v245, v245, -0.5
    v_fma_f32 v246, -v246, v246, -0.5
    v_fma_f32 v247, -v247, v247, -0.5
    v_rcp_f32 v244, v244
    v_mfma_f32_16x16x32_bf16 v[168:171], v[236:239], v[120:123], v[168:171]
    v_rcp_f32 v245, v245
    v_rcp_f32 v246, v246
    v_rcp_f32 v247, v247
    ds_read_b128 v[12:15], v250 offset:5120
    v_mfma_f32_16x16x32_bf16 v[172:175], v[236:239], v[124:127], v[172:175]
    s_add_u32 m0, s29, 1024
    s_add_u32 s31, s31, 73728
    ds_read_b64_tr_b16 v[234:235], v194 offset:17920
    buffer_load_dwordx4 v248, s[12:15], s31 offen lds
    s_waitcnt lgkmcnt(8)
    v_mfma_f32_16x16x32_bf16 v[160:163], v[224:227], v[128:131], v[160:163]
    v_fmac_f32 v48, v244, v48
    v_fmac_f32 v49, v245, v49
    v_fmac_f32 v50, v246, v50
    v_fmac_f32 v51, v247, v51
    v_cvt_pk_bf16_f32 v48, v48, v49
    ds_read_b128 v[20:23], v250 offset:3072
    v_mfma_f32_16x16x32_bf16 v[164:167], v[224:227], v[132:135], v[164:167]
    s_setprio 0
    ds_read_b64_tr_b16 v[236:237], v194 offset:25600
    v_cvt_pk_bf16_f32 v49, v50, v51
    ds_write_b64 v255, v[48:49] offset:0
    v_fma_f32 v244, v52, s56, -0.5
    v_fma_f32 v245, v53, s56, -0.5
    v_fma_f32 v246, v54, s56, -0.5
    v_mfma_f32_16x16x32_bf16 v[168:171], v[224:227], v[136:139], v[168:171]
    v_fma_f32 v247, v55, s56, -0.5
    v_exp_f32 v244, v244
    v_exp_f32 v245, v245
    v_exp_f32 v246, v246
    v_mfma_f32_16x16x32_bf16 v[172:175], v[224:227], v[140:143], v[172:175]
    ds_read_b64_tr_b16 v[238:239], v194 offset:26112
    v_exp_f32 v247, v247
    v_add_f32 v244, s57, v244
    v_add_f32 v245, s57, v245
    v_add_f32 v246, s57, v246
    v_add_f32 v247, s57, v247
    v_fma_f32 v244, -v244, v244, -0.5
    v_fma_f32 v245, -v245, v245, -0.5
    v_fma_f32 v246, -v246, v246, -0.5
    s_waitcnt lgkmcnt(8)
    v_mfma_f32_16x16x32_bf16 v[160:163], v[228:231], v[144:147], v[160:163]
    v_fma_f32 v247, -v247, v247, -0.5
    v_rcp_f32 v244, v244
    v_rcp_f32 v245, v245
    ds_read_b128 v[24:27], v250 offset:6144
    v_mfma_f32_16x16x32_bf16 v[164:167], v[228:231], v[148:151], v[164:167]
    s_waitcnt vmcnt(4) lgkmcnt(0)
    s_barrier
    s_setprio 3
    ds_read_b64_tr_b16 v[224:225], v194 offset:32768
    v_rcp_f32 v246, v246
    v_rcp_f32 v247, v247
    v_fmac_f32 v52, v244, v52
    v_fmac_f32 v53, v245, v53
    v_fmac_f32 v54, v246, v54
    v_fmac_f32 v55, v247, v55
    v_mfma_f32_16x16x32_bf16 v[168:171], v[228:231], v[152:155], v[168:171]
    v_cvt_pk_bf16_f32 v50, v52, v53
    v_cvt_pk_bf16_f32 v51, v54, v55
    ds_write_b64 v255, v[50:51] offset:1024
    ds_read_b128 v[28:31], v250 offset:7168
    v_mfma_f32_16x16x32_bf16 v[172:175], v[228:231], v[156:159], v[172:175]
    s_add_u32 m0, s29, 16384
    s_add_u32 s31, s31, 73728
    ds_read_b64_tr_b16 v[226:227], v194 offset:33280
    buffer_load_dwordx4 v248, s[12:15], s31 offen lds
    v_mfma_f32_16x16x32_bf16 v[176:179], v[232:235], v[64:67], v[176:179]
    v_fma_f32 v244, v56, s56, -0.5
    v_fma_f32 v245, v57, s56, -0.5
    v_fma_f32 v246, v58, s56, -0.5
    v_fma_f32 v247, v59, s56, -0.5
    ds_read_b128 v[32:35], v250 offset:16384
    v_mfma_f32_16x16x32_bf16 v[180:183], v[232:235], v[68:71], v[180:183]
    s_setprio 2
    ds_read_b64_tr_b16 v[228:229], v194 offset:40960
    v_exp_f32 v244, v244
    v_exp_f32 v245, v245
    v_exp_f32 v246, v246
    v_exp_f32 v247, v247
    v_add_f32 v244, s57, v244
    v_mfma_f32_16x16x32_bf16 v[184:187], v[232:235], v[72:75], v[184:187]
    v_add_f32 v245, s57, v245
    v_add_f32 v246, s57, v246
    v_add_f32 v247, s57, v247
    v_fma_f32 v244, -v244, v244, -0.5
    v_fma_f32 v245, -v245, v245, -0.5
    ds_read_b128 v[36:39], v250 offset:17408
    v_mfma_f32_16x16x32_bf16 v[188:191], v[232:235], v[76:79], v[188:191]
    ds_read_b64_tr_b16 v[230:231], v194 offset:41472
    v_fma_f32 v246, -v246, v246, -0.5
    v_fma_f32 v247, -v247, v247, -0.5
    v_rcp_f32 v244, v244
    v_rcp_f32 v245, v245
    v_rcp_f32 v246, v246
    v_mfma_f32_16x16x32_bf16 v[176:179], v[236:239], v[80:83], v[176:179]
    v_rcp_f32 v247, v247
    v_fmac_f32 v56, v244, v56
    v_fmac_f32 v57, v245, v57
    v_fmac_f32 v58, v246, v58
    v_fmac_f32 v59, v247, v59
    ds_read_b128 v[40:43], v250 offset:20480
    v_mfma_f32_16x16x32_bf16 v[180:183], v[236:239], v[84:87], v[180:183]
    s_setprio 1
    ds_read_b64_tr_b16 v[232:233], v194 offset:33792
    v_cvt_pk_bf16_f32 v52, v56, v57
    v_cvt_pk_bf16_f32 v53, v58, v59
    ds_write_b64 v255, v[52:53] offset:4096
    v_fma_f32 v244, v60, s56, -0.5
    v_fma_f32 v245, v61, s56, -0.5
    v_fma_f32 v246, v62, s56, -0.5
    v_mfma_f32_16x16x32_bf16 v[184:187], v[236:239], v[88:91], v[184:187]
    v_fma_f32 v247, v63, s56, -0.5
    v_exp_f32 v244, v244
    v_exp_f32 v245, v245
    ds_read_b128 v[44:47], v250 offset:21504
    v_mfma_f32_16x16x32_bf16 v[188:191], v[236:239], v[92:95], v[188:191]
    s_add_u32 m0, s29, 17408
    s_sub_u32 s31, s31, 294784
    ds_read_b64_tr_b16 v[234:235], v194 offset:34304
    buffer_load_dwordx4 v248, s[12:15], s31 offen lds
    s_waitcnt lgkmcnt(9)
    v_mfma_f32_16x16x32_bf16 v[176:179], v[224:227], v[96:99], v[176:179]
    v_exp_f32 v246, v246
    v_exp_f32 v247, v247
    v_add_f32 v244, s57, v244
    ds_read_b128 v[64:67], v250 offset:32768
    v_mfma_f32_16x16x32_bf16 v[180:183], v[224:227], v[100:103], v[180:183]
    s_setprio 0
    ds_read_b64_tr_b16 v[236:237], v194 offset:41984
    v_add_f32 v245, s57, v245
    v_add_f32 v246, s57, v246
    v_add_f32 v247, s57, v247
    v_fma_f32 v244, -v244, v244, -0.5
    v_fma_f32 v245, -v245, v245, -0.5
    v_fma_f32 v246, -v246, v246, -0.5
    v_fma_f32 v247, -v247, v247, -0.5
    v_rcp_f32 v244, v244
    v_mfma_f32_16x16x32_bf16 v[184:187], v[224:227], v[104:107], v[184:187]
    v_rcp_f32 v245, v245
    v_rcp_f32 v246, v246
    ds_read_b128 v[68:71], v250 offset:33792
    v_mfma_f32_16x16x32_bf16 v[188:191], v[224:227], v[108:111], v[188:191]
    ds_read_b64_tr_b16 v[238:239], v194 offset:42496
    v_rcp_f32 v247, v247
    v_fmac_f32 v60, v244, v60
    v_fmac_f32 v61, v245, v61
    v_fmac_f32 v62, v246, v62
    v_fmac_f32 v63, v247, v63
    v_cvt_pk_bf16_f32 v54, v60, v61
    v_cvt_pk_bf16_f32 v55, v62, v63
    s_waitcnt lgkmcnt(9)
    v_mfma_f32_16x16x32_bf16 v[176:179], v[228:231], v[112:115], v[176:179]
    ds_write_b64 v255, v[54:55] offset:5120
    v_add_u32 v255, 16384, v255
    ds_read_b128 v[72:75], v250 offset:36864
    ds_read_b128 v[80:83], v250 offset:34816
    v_mfma_f32_16x16x32_bf16 v[180:183], v[228:231], v[116:119], v[180:183]
    s_waitcnt vmcnt(4) lgkmcnt(0)
    s_barrier
    v_readfirstlane_b32 s40, v200
    s_nop 0
    s_cmp_lg_u32 s40, 0
    s_cbranch_scc1 L_mclr
    s_mov_b32 s101, 0
L_mclr0:
    global_load_dword v200, v201, s[54:55] sc1
    s_add_u32 s101, s101, 1
    s_cmp_ge_u32 s101, 50000
    s_cbranch_scc1 L_mclr
    s_waitcnt vmcnt(0)
    v_readfirstlane_b32 s40, v200
    s_nop 0
    s_cmp_lg_u32 s40, 0
    s_cbranch_scc0 L_mclr0
L_mclr:
    s_setprio 3
    ds_read_b64_tr_b16 v[224:225], v249 offset:49152
    v_fma_f32 v244, v160, s56, -0.5
    v_fma_f32 v245, v161, s56, -0.5
    v_fma_f32 v246, v162, s56, -0.5
    v_fma_f32 v247, v163, s56, -0.5
    v_exp_f32 v244, v244
    v_exp_f32 v245, v245
    v_mfma_f32_16x16x32_bf16 v[184:187], v[228:231], v[120:123], v[184:187]
    v_exp_f32 v246, v246
    v_exp_f32 v247, v247
    v_add_f32 v244, s57, v244
    v_add_f32 v245, s57, v245
    ds_read_b128 v[48:51], v250 offset:18432
    v_mfma_f32_16x16x32_bf16 v[188:191], v[228:231], v[124:127], v[188:191]
    s_add_u32 m0, s29, 32768
    s_add_u32 s31, s31, 73728
    ds_read_b64_tr_b16 v[226:227], v249 offset:53248
    buffer_load_dwordx4 v248, s[12:15], s31 offen lds
    v_add_f32 v246, s57, v246
    v_mfma_f32_16x16x32_bf16 v[176:179], v[232:235], v[128:131], v[176:179]
    v_add_f32 v247, s57, v247
    v_fma_f32 v244, -v244, v244, -0.5
    v_fma_f32 v245, -v245, v245, -0.5
    v_fma_f32 v246, -v246, v246, -0.5
    ds_read_b128 v[52:55], v250 offset:19456
    ds_read_b128 v[112:115], v250 offset:51200
    v_mfma_f32_16x16x32_bf16 v[180:183], v[232:235], v[132:135], v[180:183]
    s_setprio 2
    ds_read_b64_tr_b16 v[228:229], v249 offset:57344
    v_fma_f32 v247, -v247, v247, -0.5
    v_rcp_f32 v244, v244
    v_rcp_f32 v245, v245
    v_rcp_f32 v246, v246
    v_rcp_f32 v247, v247
    v_fmac_f32 v160, v244, v160
    v_mfma_f32_16x16x32_bf16 v[184:187], v[232:235], v[136:139], v[184:187]
    v_fmac_f32 v161, v245, v161
    v_fmac_f32 v162, v246, v162
    v_fmac_f32 v163, v247, v163
    v_cvt_pk_bf16_f32 v160, v160, v161
    ds_read_b128 v[56:59], v250 offset:22528
    ds_read_b128 v[116:119], v250 offset:52224
    v_mfma_f32_16x16x32_bf16 v[188:191], v[232:235], v[140:143], v[188:191]
    ds_read_b64_tr_b16 v[230:231], v249 offset:61440
    v_cvt_pk_bf16_f32 v161, v162, v163
    ds_write_b64 v255, v[160:161] offset:0
    v_fma_f32 v244, v164, s56, -0.5
    v_fma_f32 v245, v165, s56, -0.5
    v_fma_f32 v246, v166, s56, -0.5
    v_fma_f32 v247, v167, s56, -0.5
    v_mfma_f32_16x16x32_bf16 v[176:179], v[236:239], v[144:147], v[176:179]
    v_exp_f32 v244, v244
    v_exp_f32 v245, v245
    v_exp_f32 v246, v246
    ds_read_b128 v[84:87], v250 offset:35840
    v_mfma_f32_16x16x32_bf16 v[180:183], v[236:239], v[148:151], v[180:183]
    s_setprio 1
    ds_read_b64_tr_b16 v[232:233], v249 offset:50176
    v_exp_f32 v247, v247
    v_add_f32 v244, s57, v244
    v_add_f32 v245, s57, v245
    v_add_f32 v246, s57, v246
    v_add_f32 v247, s57, v247
    v_fma_f32 v244, -v244, v244, -0.5
    v_fma_f32 v245, -v245, v245, -0.5
    v_fma_f32 v246, -v246, v246, -0.5
    v_mfma_f32_16x16x32_bf16 v[184:187], v[236:239], v[152:155], v[184:187]
    v_fma_f32 v247, -v247, v247, -0.5
    v_rcp_f32 v244, v244
    v_rcp_f32 v245, v245
    ds_read_b128 v[76:79], v250 offset:37888
    v_mfma_f32_16x16x32_bf16 v[188:191], v[236:239], v[156:159], v[188:191]
    s_add_u32 m0, s29, 33792
    s_add_u32 s31, s31, 73728
    ds_read_b64_tr_b16 v[234:235], v249 offset:54272
    buffer_load_dwordx4 v248, s[12:15], s31 offen lds
    s_waitcnt lgkmcnt(11)
    v_mfma_f32_16x16x32_bf16 v[192:195], v[224:227], v[0:3], 0
    v_rcp_f32 v246, v246
    v_rcp_f32 v247, v247
    v_fmac_f32 v164, v244, v164
    ds_read_b128 v[60:63], v250 offset:23552
    ds_read_b128 v[96:99], v250 offset:49152
    v_mfma_f32_16x16x32_bf16 v[196:199], v[224:227], v[4:7], 0
    s_setprio 0
    ds_read_b64_tr_b16 v[236:237], v249 offset:58368
    v_fmac_f32 v165, v245, v165
    v_fmac_f32 v166, v246, v166
    v_fmac_f32 v167, v247, v167
    v_cvt_pk_bf16_f32 v162, v164, v165
    v_cvt_pk_bf16_f32 v163, v166, v167
    ds_write_b64 v255, v[162:163] offset:1024
    v_fma_f32 v244, v168, s56, -0.5
    v_mfma_f32_16x16x32_bf16 v[200:203], v[224:227], v[8:11], 0
    v_fma_f32 v245, v169, s56, -0.5
    v_fma_f32 v246, v170, s56, -0.5
    v_fma_f32 v247, v171, s56, -0.5
    s_waitcnt lgkmcnt(13)
    ds_read_b128 v[88:91], v250 offset:38912
    ds_read_b128 v[92:95], v250 offset:39936
    v_mfma_f32_16x16x32_bf16 v[204:207], v[224:227], v[12:15], 0
    s_waitcnt lgkmcnt(13)
    ds_read_b64_tr_b16 v[238:239], v249 offset:62464
    v_exp_f32 v244, v244
    v_exp_f32 v245, v245
    v_exp_f32 v246, v246
    v_exp_f32 v247, v247
    v_add_f32 v244, s57, v244
    v_add_f32 v245, s57, v245
    s_waitcnt lgkmcnt(12)
    v_mfma_f32_16x16x32_bf16 v[192:195], v[228:231], v[16:19], v[192:195]
    v_add_f32 v246, s57, v246
    v_add_f32 v247, s57, v247
    v_fma_f32 v244, -v244, v244, -0.5
    v_fma_f32 v245, -v245, v245, -0.5
    ds_read_b128 v[100:103], v250 offset:50176
    ds_read_b128 v[120:123], v250 offset:55296
    v_mfma_f32_16x16x32_bf16 v[196:199], v[228:231], v[20:23], v[196:199]
    s_waitcnt vmcnt(4) lgkmcnt(0)
    s_barrier
    s_setprio 3
    ds_read_b64_tr_b16 v[224:225], v249 offset:0
    v_fma_f32 v246, -v246, v246, -0.5
    v_fma_f32 v247, -v247, v247, -0.5
    v_rcp_f32 v244, v244
    v_rcp_f32 v245, v245
    v_rcp_f32 v246, v246
    v_rcp_f32 v247, v247
    v_mfma_f32_16x16x32_bf16 v[200:203], v[228:231], v[24:27], v[200:203]
    v_fmac_f32 v168, v244, v168
    v_fmac_f32 v169, v245, v169
    v_fmac_f32 v170, v246, v170
    v_fmac_f32 v171, v247, v171
    ds_read_b128 v[104:107], v250 offset:53248
    ds_read_b128 v[124:127], v250 offset:56320
    v_mfma_f32_16x16x32_bf16 v[204:207], v[228:231], v[28:31], v[204:207]
    s_add_u32 m0, s29, 49152
    s_add_u32 s31, s31, 73728
    ds_read_b64_tr_b16 v[226:227], v249 offset:4096
    buffer_load_dwordx4 v248, s[12:15], s31 offen lds
    v_mfma_f32_16x16x32_bf16 v[192:195], v[232:235], v[32:35], v[192:195]
    v_cvt_pk_bf16_f32 v164, v168, v169
    v_cvt_pk_bf16_f32 v165, v170, v171
    ds_write_b64 v255, v[164:165] offset:4096
    ds_read_b128 v[108:111], v250 offset:54272
    v_mfma_f32_16x16x32_bf16 v[196:199], v[232:235], v[36:39], v[196:199]
    s_setprio 2
    ds_read_b64_tr_b16 v[228:229], v249 offset:8192
    v_fma_f32 v244, v172, s56, -0.5
    v_fma_f32 v245, v173, s56, -0.5
    v_fma_f32 v246, v174, s56, -0.5
    v_fma_f32 v247, v175, s56, -0.5
    v_exp_f32 v244, v244
    v_exp_f32 v245, v245
    v_mfma_f32_16x16x32_bf16 v[200:203], v[232:235], v[40:43], v[200:203]
    v_exp_f32 v246, v246
    v_exp_f32 v247, v247
    v_add_f32 v244, s57, v244
    v_add_f32 v245, s57, v245
    v_mfma_f32_16x16x32_bf16 v[204:207], v[232:235], v[44:47], v[204:207]
    ds_read_b64_tr_b16 v[230:231], v249 offset:12288
    v_add_f32 v246, s57, v246
    v_add_f32 v247, s57, v247
    v_fma_f32 v244, -v244, v244, -0.5
    v_fma_f32 v245, -v245, v245, -0.5
    v_fma_f32 v246, -v246, v246, -0.5
    v_fma_f32 v247, -v247, v247, -0.5
    v_rcp_f32 v244, v244
    v_mfma_f32_16x16x32_bf16 v[192:195], v[236:239], v[48:51], v[192:195]
    v_rcp_f32 v245, v245
    v_rcp_f32 v246, v246
    v_rcp_f32 v247, v247
    v_mfma_f32_16x16x32_bf16 v[196:199], v[236:239], v[52:55], v[196:199]
    s_setprio 1
    ds_read_b64_tr_b16 v[232:233], v249 offset:1024
    v_fmac_f32 v172, v244, v172
    v_fmac_f32 v173, v245, v173
    v_fmac_f32 v174, v246, v174
    v_fmac_f32 v175, v247, v175
    v_cvt_pk_bf16_f32 v166, v172, v173
    v_mfma_f32_16x16x32_bf16 v[200:203], v[236:239], v[56:59], v[200:203]
    v_cvt_pk_bf16_f32 v167, v174, v175
    ds_write_b64 v255, v[166:167] offset:5120
    v_add_u32 v255, 16384, v255
    v_mfma_f32_16x16x32_bf16 v[204:207], v[236:239], v[60:63], v[204:207]
    s_add_u32 m0, s29, 50176
    s_add_u32 s31, s31, 73728
    ds_read_b64_tr_b16 v[234:235], v249 offset:5120
    s_waitcnt lgkmcnt(7)
    v_mfma_f32_16x16x32_bf16 v[192:195], v[224:227], v[64:67], v[192:195]
    buffer_load_dwordx4 v248, s[12:15], s31 offen lds
    v_mfma_f32_16x16x32_bf16 v[196:199], v[224:227], v[68:71], v[196:199]
    s_setprio 0
    ds_read_b64_tr_b16 v[236:237], v249 offset:9216
    v_fma_f32 v244, v176, s56, -0.5
    v_fma_f32 v245, v177, s56, -0.5
    v_fma_f32 v246, v178, s56, -0.5
    v_fma_f32 v247, v179, s56, -0.5
    v_mfma_f32_16x16x32_bf16 v[200:203], v[224:227], v[72:75], v[200:203]
    v_exp_f32 v244, v244
    v_exp_f32 v245, v245
    v_mfma_f32_16x16x32_bf16 v[204:207], v[224:227], v[76:79], v[204:207]
    ds_read_b64_tr_b16 v[238:239], v249 offset:13312
    v_exp_f32 v246, v246
    v_exp_f32 v247, v247
    s_waitcnt lgkmcnt(5)
    v_mfma_f32_16x16x32_bf16 v[192:195], v[228:231], v[80:83], v[192:195]
    v_add_f32 v244, s57, v244
    v_add_f32 v245, s57, v245
    v_add_f32 v246, s57, v246
    v_add_f32 v247, s57, v247
    v_mfma_f32_16x16x32_bf16 v[196:199], v[228:231], v[84:87], v[196:199]
    s_waitcnt vmcnt(4) lgkmcnt(0)
    s_barrier
    s_setprio 3
    ds_read_b64_tr_b16 v[224:225], v249 offset:16384
    v_fma_f32 v244, -v244, v244, -0.5
    v_fma_f32 v245, -v245, v245, -0.5
    v_fma_f32 v246, -v246, v246, -0.5
    v_fma_f32 v247, -v247, v247, -0.5
    v_rcp_f32 v244, v244
    v_mfma_f32_16x16x32_bf16 v[200:203], v[228:231], v[88:91], v[200:203]
    v_rcp_f32 v245, v245
    ds_read_b128 v[128:131], v240 offset:0
    v_mfma_f32_16x16x32_bf16 v[204:207], v[228:231], v[92:95], v[204:207]
    s_add_u32 m0, s29, 0
    s_add_u32 s31, s31, 73600
    ds_read_b64_tr_b16 v[226:227], v249 offset:20480
    buffer_load_dwordx4 v248, s[12:15], s31 offen lds
    v_mfma_f32_16x16x32_bf16 v[192:195], v[232:235], v[96:99], v[192:195]
    ds_read_b128 v[132:135], v240 offset:1024
    v_mfma_f32_16x16x32_bf16 v[196:199], v[232:235], v[100:103], v[196:199]
    s_setprio 2
    ds_read_b64_tr_b16 v[228:229], v249 offset:24576
    v_rcp_f32 v246, v246
    v_rcp_f32 v247, v247
    v_fmac_f32 v176, v244, v176
    v_mfma_f32_16x16x32_bf16 v[200:203], v[232:235], v[104:107], v[200:203]
    v_fmac_f32 v177, v245, v177
    v_fmac_f32 v178, v246, v178
    v_fmac_f32 v179, v247, v179
    ds_read_b128 v[136:139], v240 offset:4096
    v_mfma_f32_16x16x32_bf16 v[204:207], v[232:235], v[108:111], v[204:207]
    ds_read_b64_tr_b16 v[230:231], v249 offset:28672
    v_cvt_pk_bf16_f32 v176, v176, v177
    v_cvt_pk_bf16_f32 v177, v178, v179
    ds_write_b64 v255, v[176:177] offset:0
    v_fma_f32 v244, v180, s56, -0.5
    v_mfma_f32_16x16x32_bf16 v[192:195], v[236:239], v[112:115], v[192:195]
    v_fma_f32 v245, v181, s56, -0.5
    ds_read_b128 v[140:143], v240 offset:5120
    ds_read_b128 v[144:147], v240 offset:2048
    v_mfma_f32_16x16x32_bf16 v[196:199], v[236:239], v[116:119], v[196:199]
    s_setprio 1
    ds_read_b64_tr_b16 v[232:233], v249 offset:17408
    v_fma_f32 v246, v182, s56, -0.5
    v_fma_f32 v247, v183, s56, -0.5
    v_exp_f32 v244, v244
    v_exp_f32 v245, v245
    v_mfma_f32_16x16x32_bf16 v[200:203], v[236:239], v[120:123], v[200:203]
    v_exp_f32 v246, v246
    ds_read_b128 v[148:151], v240 offset:3072
    ds_read_b128 v[152:155], v240 offset:6144
    v_mfma_f32_16x16x32_bf16 v[204:207], v[236:239], v[124:127], v[204:207]
    s_add_u32 m0, s29, 1024
    s_add_u32 s31, s31, 128
    ds_read_b64_tr_b16 v[234:235], v249 offset:21504
    buffer_load_dwordx4 v248, s[12:15], s31 offen lds
    s_waitcnt lgkmcnt(10)
    v_mfma_f32_16x16x32_bf16 v[192:195], v[224:227], v[128:131], v[192:195]
    ds_read_b128 v[156:159], v240 offset:7168
    v_mfma_f32_16x16x32_bf16 v[196:199], v[224:227], v[132:135], v[196:199]
    s_setprio 0
    ds_read_b64_tr_b16 v[236:237], v249 offset:25600
    v_exp_f32 v247, v247
    v_add_f32 v244, s57, v244
    v_add_f32 v245, s57, v245
    s_waitcnt lgkmcnt(7)
    v_mfma_f32_16x16x32_bf16 v[200:203], v[224:227], v[136:139], v[200:203]
    v_add_f32 v246, s57, v246
    v_add_f32 v247, s57, v247
    v_fma_f32 v244, -v244, v244, -0.5
    v_mfma_f32_16x16x32_bf16 v[204:207], v[224:227], v[140:143], v[204:207]
    ds_read_b64_tr_b16 v[238:239], v249 offset:29696
    v_fma_f32 v245, -v245, v245, -0.5
    v_fma_f32 v246, -v246, v246, -0.5
    v_fma_f32 v247, -v247, v247, -0.5
    s_waitcnt lgkmcnt(5)
    v_mfma_f32_16x16x32_bf16 v[192:195], v[228:231], v[144:147], v[192:195]
    v_rcp_f32 v244, v244
    v_rcp_f32 v245, v245
    v_mfma_f32_16x16x32_bf16 v[196:199], v[228:231], v[148:151], v[196:199]
    s_waitcnt vmcnt(4) lgkmcnt(0)
    s_barrier
    s_setprio 3
    ds_read_b64_tr_b16 v[224:225], v249 offset:32768
    v_rcp_f32 v246, v246
    v_rcp_f32 v247, v247
    v_mfma_f32_16x16x32_bf16 v[200:203], v[228:231], v[152:155], v[200:203]
    v_fmac_f32 v180, v244, v180
    v_fmac_f32 v181, v245, v181
    v_fmac_f32 v182, v246, v182
    v_fmac_f32 v183, v247, v183
    v_mfma_f32_16x16x32_bf16 v[204:207], v[228:231], v[156:159], v[204:207]
    s_add_u32 m0, s29, 16384
    s_sub_u32 s31, s31, 368512
    ds_read_b64_tr_b16 v[226:227], v249 offset:36864
    v_mfma_f32_16x16x32_bf16 v[208:211], v[232:235], v[0:3], 0
    buffer_load_dwordx4 v248, s[12:15], s31 offen lds
    v_mfma_f32_16x16x32_bf16 v[212:215], v[232:235], v[4:7], 0
    s_setprio 2
    ds_read_b64_tr_b16 v[228:229], v249 offset:40960
    v_cvt_pk_bf16_f32 v178, v180, v181
    v_cvt_pk_bf16_f32 v179, v182, v183
    ds_write_b64 v255, v[178:179] offset:1024
    v_mfma_f32_16x16x32_bf16 v[216:219], v[232:235], v[8:11], 0
    v_fma_f32 v244, v184, s56, -0.5
    v_fma_f32 v245, v185, s56, -0.5
    v_mfma_f32_16x16x32_bf16 v[220:223], v[232:235], v[12:15], 0
    ds_read_b64_tr_b16 v[230:231], v249 offset:45056
    v_fma_f32 v246, v186, s56, -0.5
    v_fma_f32 v247, v187, s56, -0.5
    v_exp_f32 v244, v244
    v_mfma_f32_16x16x32_bf16 v[208:211], v[236:239], v[16:19], v[208:211]
    v_exp_f32 v245, v245
    v_exp_f32 v246, v246
    v_mfma_f32_16x16x32_bf16 v[212:215], v[236:239], v[20:23], v[212:215]
    s_setprio 1
    ds_read_b64_tr_b16 v[232:233], v249 offset:33792
    v_exp_f32 v247, v247
    v_add_f32 v244, s57, v244
    v_add_f32 v245, s57, v245
    v_mfma_f32_16x16x32_bf16 v[216:219], v[236:239], v[24:27], v[216:219]
    v_add_f32 v246, s57, v246
    v_add_f32 v247, s57, v247
    v_fma_f32 v244, -v244, v244, -0.5
    v_mfma_f32_16x16x32_bf16 v[220:223], v[236:239], v[28:31], v[220:223]
    s_add_u32 m0, s29, 17408
    s_add_u32 s31, s31, 73728
    ds_read_b64_tr_b16 v[234:235], v249 offset:37888
    s_waitcnt lgkmcnt(5)
    v_mfma_f32_16x16x32_bf16 v[208:211], v[224:227], v[32:35], v[208:211]
    buffer_load_dwordx4 v248, s[12:15], s31 offen lds
    v_mfma_f32_16x16x32_bf16 v[212:215], v[224:227], v[36:39], v[212:215]
    s_setprio 0
    ds_read_b64_tr_b16 v[236:237], v249 offset:41984
    v_fma_f32 v245, -v245, v245, -0.5
    v_fma_f32 v246, -v246, v246, -0.5
    v_fma_f32 v247, -v247, v247, -0.5
    v_mfma_f32_16x16x32_bf16 v[216:219], v[224:227], v[40:43], v[216:219]
    v_rcp_f32 v244, v244
    v_rcp_f32 v245, v245
    v_mfma_f32_16x16x32_bf16 v[220:223], v[224:227], v[44:47], v[220:223]
    ds_read_b64_tr_b16 v[238:239], v249 offset:46080
    v_rcp_f32 v246, v246
    v_rcp_f32 v247, v247
    s_waitcnt lgkmcnt(4)
    v_mfma_f32_16x16x32_bf16 v[208:211], v[228:231], v[48:51], v[208:211]
    v_fmac_f32 v184, v244, v184
    v_fmac_f32 v185, v245, v185
    v_fmac_f32 v186, v246, v186
    v_fmac_f32 v187, v247, v187
    v_mfma_f32_16x16x32_bf16 v[212:215], v[228:231], v[52:55], v[212:215]
    s_waitcnt vmcnt(4) lgkmcnt(0)
    s_barrier
    s_setprio 3
    ds_read_b64_tr_b16 v[224:225], v249 offset:49152
    v_cvt_pk_bf16_f32 v180, v184, v185
    v_cvt_pk_bf16_f32 v181, v186, v187
    ds_write_b64 v255, v[180:181] offset:4096
    v_mfma_f32_16x16x32_bf16 v[216:219], v[228:231], v[56:59], v[216:219]
    v_fma_f32 v244, v188, s56, -0.5
    v_fma_f32 v245, v189, s56, -0.5
    v_mfma_f32_16x16x32_bf16 v[220:223], v[228:231], v[60:63], v[220:223]
    s_add_u32 m0, s29, 32768
    s_add_u32 s31, s31, 73728
    ds_read_b64_tr_b16 v[226:227], v249 offset:53248
    v_mfma_f32_16x16x32_bf16 v[208:211], v[232:235], v[64:67], v[208:211]
    buffer_load_dwordx4 v248, s[12:15], s31 offen lds
    v_mfma_f32_16x16x32_bf16 v[212:215], v[232:235], v[68:71], v[212:215]
    s_setprio 2
    ds_read_b64_tr_b16 v[228:229], v249 offset:57344
    v_fma_f32 v246, v190, s56, -0.5
    v_fma_f32 v247, v191, s56, -0.5
    v_exp_f32 v244, v244
    v_mfma_f32_16x16x32_bf16 v[216:219], v[232:235], v[72:75], v[216:219]
    v_exp_f32 v245, v245
    v_exp_f32 v246, v246
    v_mfma_f32_16x16x32_bf16 v[220:223], v[232:235], v[76:79], v[220:223]
    ds_read_b64_tr_b16 v[230:231], v249 offset:61440
    v_exp_f32 v247, v247
    v_add_f32 v244, s57, v244
    v_add_f32 v245, s57, v245
    v_mfma_f32_16x16x32_bf16 v[208:211], v[236:239], v[80:83], v[208:211]
    v_add_f32 v246, s57, v246
    v_add_f32 v247, s57, v247
    v_fma_f32 v244, -v244, v244, -0.5
    v_mfma_f32_16x16x32_bf16 v[212:215], v[236:239], v[84:87], v[212:215]
    s_setprio 1
    ds_read_b64_tr_b16 v[232:233], v249 offset:50176
    v_fma_f32 v245, -v245, v245, -0.5
    v_fma_f32 v246, -v246, v246, -0.5
    v_fma_f32 v247, -v247, v247, -0.5
    v_mfma_f32_16x16x32_bf16 v[216:219], v[236:239], v[88:91], v[216:219]
    v_rcp_f32 v244, v244
    v_rcp_f32 v245, v245
    v_mfma_f32_16x16x32_bf16 v[220:223], v[236:239], v[92:95], v[220:223]
    s_add_u32 m0, s29, 33792
    s_add_u32 s31, s31, 73728
    ds_read_b64_tr_b16 v[234:235], v249 offset:54272
    s_waitcnt lgkmcnt(4)
    v_mfma_f32_16x16x32_bf16 v[208:211], v[224:227], v[96:99], v[208:211]
    buffer_load_dwordx4 v248, s[12:15], s31 offen lds
    v_mfma_f32_16x16x32_bf16 v[212:215], v[224:227], v[100:103], v[212:215]
    s_setprio 0
    ds_read_b64_tr_b16 v[236:237], v249 offset:58368
    v_rcp_f32 v246, v246
    v_rcp_f32 v247, v247
    v_mfma_f32_16x16x32_bf16 v[216:219], v[224:227], v[104:107], v[216:219]
    v_fmac_f32 v188, v244, v188
    v_fmac_f32 v189, v245, v189
    v_fmac_f32 v190, v246, v190
    v_fmac_f32 v191, v247, v191
    v_mfma_f32_16x16x32_bf16 v[220:223], v[224:227], v[108:111], v[220:223]
    ds_read_b64_tr_b16 v[238:239], v249 offset:62464
    v_cvt_pk_bf16_f32 v182, v188, v189
    v_cvt_pk_bf16_f32 v183, v190, v191
    s_waitcnt lgkmcnt(4)
    v_mfma_f32_16x16x32_bf16 v[208:211], v[228:231], v[112:115], v[208:211]
    ds_write_b64 v255, v[182:183] offset:5120
    v_mfma_f32_16x16x32_bf16 v[212:215], v[228:231], v[116:119], v[212:215]
    s_waitcnt vmcnt(4) lgkmcnt(0)
    s_barrier
    ds_read_b64_tr_b16 v[224:225], v249 offset:0
    ds_read_b128 v[160:163], v240 offset:16384
    v_mfma_f32_16x16x32_bf16 v[216:219], v[228:231], v[120:123], v[216:219]
    ds_read_b128 v[164:167], v240 offset:17408
    v_mfma_f32_16x16x32_bf16 v[220:223], v[228:231], v[124:127], v[220:223]
    s_add_u32 m0, s29, 49152
    s_add_u32 s31, s31, 73728
    ds_read_b64_tr_b16 v[226:227], v249 offset:4096
    v_mfma_f32_16x16x32_bf16 v[208:211], v[232:235], v[128:131], v[208:211]
    buffer_load_dwordx4 v248, s[12:15], s31 offen lds
    v_mfma_f32_16x16x32_bf16 v[212:215], v[232:235], v[132:135], v[212:215]
    ds_read_b64_tr_b16 v[228:229], v249 offset:8192
    ds_read_b128 v[168:171], v240 offset:20480
    v_mfma_f32_16x16x32_bf16 v[216:219], v[232:235], v[136:139], v[216:219]
    ds_read_b128 v[172:175], v240 offset:21504
    v_mfma_f32_16x16x32_bf16 v[220:223], v[232:235], v[140:143], v[220:223]
    ds_read_b64_tr_b16 v[230:231], v249 offset:12288
    ds_read_b128 v[176:179], v240 offset:18432
    v_mfma_f32_16x16x32_bf16 v[208:211], v[236:239], v[144:147], v[208:211]
    ds_read_b128 v[180:183], v240 offset:19456
    v_mfma_f32_16x16x32_bf16 v[212:215], v[236:239], v[148:151], v[212:215]
    ds_read_b64_tr_b16 v[232:233], v249 offset:1024
    ds_read_b128 v[184:187], v240 offset:22528
    v_mfma_f32_16x16x32_bf16 v[216:219], v[236:239], v[152:155], v[216:219]
    ds_read_b128 v[188:191], v240 offset:23552
    v_mfma_f32_16x16x32_bf16 v[220:223], v[236:239], v[156:159], v[220:223]
    s_add_u32 m0, s29, 50176
    s_add_u32 s31, s31, 73728
    ds_read_b64_tr_b16 v[234:235], v249 offset:5120
    s_waitcnt lgkmcnt(10)
    v_mfma_f32_16x16x32_bf16 v[192:195], v[224:227], v[160:163], v[192:195]
    buffer_load_dwordx4 v248, s[12:15], s31 offen lds
    v_mfma_f32_16x16x32_bf16 v[196:199], v[224:227], v[164:167], v[196:199]
    ds_read_b64_tr_b16 v[236:237], v249 offset:9216
    s_waitcnt lgkmcnt(8)
    v_mfma_f32_16x16x32_bf16 v[200:203], v[224:227], v[168:171], v[200:203]
    v_mfma_f32_16x16x32_bf16 v[204:207], v[224:227], v[172:175], v[204:207]
    ds_read_b64_tr_b16 v[238:239], v249 offset:13312
    s_waitcnt lgkmcnt(6)
    v_mfma_f32_16x16x32_bf16 v[192:195], v[228:231], v[176:179], v[192:195]
    v_mfma_f32_16x16x32_bf16 v[196:199], v[228:231], v[180:183], v[196:199]
    s_waitcnt vmcnt(4) lgkmcnt(0)
    s_barrier
    ds_read_b64_tr_b16 v[224:225], v249 offset:16384
    v_mfma_f32_16x16x32_bf16 v[200:203], v[228:231], v[184:187], v[200:203]
    v_mfma_f32_16x16x32_bf16 v[204:207], v[228:231], v[188:191], v[204:207]
    s_add_u32 m0, s29, 0
    s_sub_u32 s31, s31, 368512
    ds_read_b64_tr_b16 v[226:227], v249 offset:20480
    v_mfma_f32_16x16x32_bf16 v[208:211], v[232:235], v[160:163], v[208:211]
    buffer_load_dwordx4 v248, s[12:15], s31 offen lds
    v_mfma_f32_16x16x32_bf16 v[212:215], v[232:235], v[164:167], v[212:215]
    ds_read_b64_tr_b16 v[228:229], v249 offset:24576
    v_mfma_f32_16x16x32_bf16 v[216:219], v[232:235], v[168:171], v[216:219]
    v_mfma_f32_16x16x32_bf16 v[220:223], v[232:235], v[172:175], v[220:223]
    ds_read_b64_tr_b16 v[230:231], v249 offset:28672
    v_mfma_f32_16x16x32_bf16 v[208:211], v[236:239], v[176:179], v[208:211]
    v_mfma_f32_16x16x32_bf16 v[212:215], v[236:239], v[180:183], v[212:215]
    ds_read_b64_tr_b16 v[232:233], v249 offset:17408
    v_cvt_pk_bf16_f32 v240, v192, v193
    v_cvt_pk_bf16_f32 v241, v194, v195
    v_mfma_f32_16x16x32_bf16 v[216:219], v[236:239], v[184:187], v[216:219]
    v_cvt_pk_bf16_f32 v242, v196, v197
    v_cvt_pk_bf16_f32 v243, v198, v199
    v_mfma_f32_16x16x32_bf16 v[220:223], v[236:239], v[188:191], v[220:223]
    s_add_u32 m0, s29, 1024
    s_add_u32 s31, s31, 73728
    ds_read_b64_tr_b16 v[234:235], v249 offset:21504
    buffer_load_dwordx4 v248, s[12:15], s31 offen lds
    s_waitcnt lgkmcnt(4)
    v_mfma_f32_16x16x32_bf16 v[192:195], v[224:227], v[0:3], 0
    v_cvt_pk_bf16_f32 v244, v200, v201
    v_cvt_pk_bf16_f32 v245, v202, v203
    v_cvt_pk_bf16_f32 v246, v204, v205
    v_cvt_pk_bf16_f32 v247, v206, v207
    v_mfma_f32_16x16x32_bf16 v[196:199], v[224:227], v[4:7], 0
    ds_read_b64_tr_b16 v[236:237], v249 offset:25600
    v_mfma_f32_16x16x32_bf16 v[200:203], v[224:227], v[8:11], 0
    buffer_store_dwordx4 v[240:243], v251, s[20:23], s34 offen sc1
    v_mfma_f32_16x16x32_bf16 v[204:207], v[224:227], v[12:15], 0
    ds_read_b64_tr_b16 v[238:239], v249 offset:29696
    s_waitcnt lgkmcnt(4)
    v_mfma_f32_16x16x32_bf16 v[192:195], v[228:231], v[16:19], v[192:195]
    buffer_store_dwordx4 v[244:247], v251, s[20:23], s37 offen sc1
    v_mfma_f32_16x16x32_bf16 v[196:199], v[228:231], v[20:23], v[196:199]
    s_waitcnt vmcnt(6) lgkmcnt(0)
    s_barrier
    ds_read_b64_tr_b16 v[224:225], v249 offset:32768
    v_mfma_f32_16x16x32_bf16 v[200:203], v[228:231], v[24:27], v[200:203]
    s_add_u32 s34, s34, 3145728
    s_add_u32 s37, s37, 3145728
    v_mfma_f32_16x16x32_bf16 v[204:207], v[228:231], v[28:31], v[204:207]
    s_add_u32 m0, s29, 16384
    s_add_u32 s31, s31, 73728
    ds_read_b64_tr_b16 v[226:227], v249 offset:36864
    v_mfma_f32_16x16x32_bf16 v[192:195], v[232:235], v[32:35], v[192:195]
    buffer_load_dwordx4 v248, s[12:15], s31 offen lds
    v_mfma_f32_16x16x32_bf16 v[196:199], v[232:235], v[36:39], v[196:199]
    ds_read_b64_tr_b16 v[228:229], v249 offset:40960
    v_cvt_pk_bf16_f32 v240, v208, v209
    v_cvt_pk_bf16_f32 v241, v210, v211
    v_cvt_pk_bf16_f32 v242, v212, v213
    v_mfma_f32_16x16x32_bf16 v[200:203], v[232:235], v[40:43], v[200:203]
    v_cvt_pk_bf16_f32 v243, v214, v215
    v_cvt_pk_bf16_f32 v244, v216, v217
    v_cvt_pk_bf16_f32 v245, v218, v219
    v_mfma_f32_16x16x32_bf16 v[204:207], v[232:235], v[44:47], v[204:207]
    ds_read_b64_tr_b16 v[230:231], v249 offset:45056
    v_mfma_f32_16x16x32_bf16 v[192:195], v[236:239], v[48:51], v[192:195]
    v_cvt_pk_bf16_f32 v246, v220, v221
    v_cvt_pk_bf16_f32 v247, v222, v223
    v_mfma_f32_16x16x32_bf16 v[196:199], v[236:239], v[52:55], v[196:199]
    ds_read_b64_tr_b16 v[232:233], v249 offset:33792
    v_mfma_f32_16x16x32_bf16 v[200:203], v[236:239], v[56:59], v[200:203]
    buffer_store_dwordx4 v[240:243], v251, s[20:23], s34 offen sc1
    v_mfma_f32_16x16x32_bf16 v[204:207], v[236:239], v[60:63], v[204:207]
    s_add_u32 m0, s29, 17408
    s_add_u32 s31, s31, 73728
    ds_read_b64_tr_b16 v[234:235], v249 offset:37888
    s_waitcnt lgkmcnt(4)
    v_mfma_f32_16x16x32_bf16 v[192:195], v[224:227], v[64:67], v[192:195]
    buffer_load_dwordx4 v248, s[12:15], s31 offen lds
    v_mfma_f32_16x16x32_bf16 v[196:199], v[224:227], v[68:71], v[196:199]
    ds_read_b64_tr_b16 v[236:237], v249 offset:41984
    v_mfma_f32_16x16x32_bf16 v[200:203], v[224:227], v[72:75], v[200:203]
    buffer_store_dwordx4 v[244:247], v251, s[20:23], s37 offen sc1
    v_mfma_f32_16x16x32_bf16 v[204:207], v[224:227], v[76:79], v[204:207]
    ds_read_b64_tr_b16 v[238:239], v249 offset:46080
    s_waitcnt lgkmcnt(4)
    v_mfma_f32_16x16x32_bf16 v[192:195], v[228:231], v[80:83], v[192:195]
    s_add_u32 s34, s34, 3145728
    s_add_u32 s37, s37, 3145728
    v_mfma_f32_16x16x32_bf16 v[196:199], v[228:231], v[84:87], v[196:199]
    s_waitcnt vmcnt(8) lgkmcnt(0)
    s_barrier
    ds_read_b64_tr_b16 v[224:225], v249 offset:49152
    v_mfma_f32_16x16x32_bf16 v[200:203], v[228:231], v[88:91], v[200:203]
    v_mfma_f32_16x16x32_bf16 v[204:207], v[228:231], v[92:95], v[204:207]
    s_add_u32 m0, s29, 32768
    s_add_u32 s31, s31, 73728
    ds_read_b64_tr_b16 v[226:227], v249 offset:53248
    v_mfma_f32_16x16x32_bf16 v[192:195], v[232:235], v[96:99], v[192:195]
    buffer_load_dwordx4 v248, s[12:15], s31 offen lds
    v_mfma_f32_16x16x32_bf16 v[196:199], v[232:235], v[100:103], v[196:199]
    ds_read_b64_tr_b16 v[228:229], v249 offset:57344
    v_mfma_f32_16x16x32_bf16 v[200:203], v[232:235], v[104:107], v[200:203]
    v_mfma_f32_16x16x32_bf16 v[204:207], v[232:235], v[108:111], v[204:207]
    ds_read_b64_tr_b16 v[230:231], v249 offset:61440
    v_mfma_f32_16x16x32_bf16 v[192:195], v[236:239], v[112:115], v[192:195]
    v_mfma_f32_16x16x32_bf16 v[196:199], v[236:239], v[116:119], v[196:199]
    ds_read_b64_tr_b16 v[232:233], v249 offset:50176
    v_mfma_f32_16x16x32_bf16 v[200:203], v[236:239], v[120:123], v[200:203]
    v_mfma_f32_16x16x32_bf16 v[204:207], v[236:239], v[124:127], v[204:207]
    s_add_u32 m0, s29, 33792
    s_add_u32 s31, s31, 73728
    ds_read_b64_tr_b16 v[234:235], v249 offset:54272
    s_waitcnt lgkmcnt(4)
    v_mfma_f32_16x16x32_bf16 v[192:195], v[224:227], v[128:131], v[192:195]
    buffer_load_dwordx4 v248, s[12:15], s31 offen lds
    v_mfma_f32_16x16x32_bf16 v[196:199], v[224:227], v[132:135], v[196:199]
    ds_read_b64_tr_b16 v[236:237], v249 offset:58368
    v_mfma_f32_16x16x32_bf16 v[200:203], v[224:227], v[136:139], v[200:203]
    v_mfma_f32_16x16x32_bf16 v[204:207], v[224:227], v[140:143], v[204:207]
    ds_read_b64_tr_b16 v[238:239], v249 offset:62464
    s_waitcnt lgkmcnt(4)
    v_mfma_f32_16x16x32_bf16 v[192:195], v[228:231], v[144:147], v[192:195]
    v_mfma_f32_16x16x32_bf16 v[196:199], v[228:231], v[148:151], v[196:199]
    s_waitcnt vmcnt(6) lgkmcnt(0)
    s_barrier
    v_add_u32 v254, 1, v254
    buffer_store_dword v254, v253, s[20:23], s36 offen sc1
    ds_read_b64_tr_b16 v[224:225], v249 offset:0
    v_mfma_f32_16x16x32_bf16 v[200:203], v[228:231], v[152:155], v[200:203]
    v_mfma_f32_16x16x32_bf16 v[204:207], v[228:231], v[156:159], v[204:207]
    s_add_u32 m0, s29, 49152
    s_sub_u32 s31, s31, 368512
    ds_read_b64_tr_b16 v[226:227], v249 offset:4096
    v_mfma_f32_16x16x32_bf16 v[192:195], v[232:235], v[160:163], v[192:195]
    buffer_load_dwordx4 v248, s[12:15], s31 offen lds
    v_mfma_f32_16x16x32_bf16 v[196:199], v[232:235], v[164:167], v[196:199]
    ds_read_b64_tr_b16 v[228:229], v249 offset:8192
    v_mfma_f32_16x16x32_bf16 v[200:203], v[232:235], v[168:171], v[200:203]
    v_mfma_f32_16x16x32_bf16 v[204:207], v[232:235], v[172:175], v[204:207]
    ds_read_b64_tr_b16 v[230:231], v249 offset:12288
    v_mfma_f32_16x16x32_bf16 v[192:195], v[236:239], v[176:179], v[192:195]
    v_mfma_f32_16x16x32_bf16 v[196:199], v[236:239], v[180:183], v[196:199]
    ds_read_b64_tr_b16 v[232:233], v249 offset:1024
    v_mfma_f32_16x16x32_bf16 v[200:203], v[236:239], v[184:187], v[200:203]
    v_mfma_f32_16x16x32_bf16 v[204:207], v[236:239], v[188:191], v[204:207]
    s_add_u32 m0, s29, 50176
    s_add_u32 s31, s31, 73728
    ds_read_b64_tr_b16 v[234:235], v249 offset:5120
    s_waitcnt lgkmcnt(4)
    v_mfma_f32_16x16x32_bf16 v[208:211], v[224:227], v[0:3], 0
    buffer_load_dwordx4 v248, s[12:15], s31 offen lds
    v_mfma_f32_16x16x32_bf16 v[212:215], v[224:227], v[4:7], 0
    ds_read_b64_tr_b16 v[236:237], v249 offset:9216
    v_mfma_f32_16x16x32_bf16 v[216:219], v[224:227], v[8:11], 0
    v_mfma_f32_16x16x32_bf16 v[220:223], v[224:227], v[12:15], 0
    ds_read_b64_tr_b16 v[238:239], v249 offset:13312
    s_waitcnt lgkmcnt(4)
    v_mfma_f32_16x16x32_bf16 v[208:211], v[228:231], v[16:19], v[208:211]
    v_mfma_f32_16x16x32_bf16 v[212:215], v[228:231], v[20:23], v[212:215]
    s_waitcnt vmcnt(5) lgkmcnt(0)
    s_barrier
    v_add_u32 v254, 1, v254
    buffer_store_dword v254, v253, s[20:23], s36 offen sc1
    ds_read_b64_tr_b16 v[224:225], v249 offset:16384
    v_mfma_f32_16x16x32_bf16 v[216:219], v[228:231], v[24:27], v[216:219]
    v_mfma_f32_16x16x32_bf16 v[220:223], v[228:231], v[28:31], v[220:223]
    s_add_u32 m0, s29, 0
    s_add_u32 s31, s31, 73728
    ds_read_b64_tr_b16 v[226:227], v249 offset:20480
    v_mfma_f32_16x16x32_bf16 v[208:211], v[232:235], v[32:35], v[208:211]
    buffer_load_dwordx4 v248, s[12:15], s31 offen lds
    v_mfma_f32_16x16x32_bf16 v[212:215], v[232:235], v[36:39], v[212:215]
    ds_read_b64_tr_b16 v[228:229], v249 offset:24576
    v_cvt_pk_bf16_f32 v240, v192, v193
    v_cvt_pk_bf16_f32 v241, v194, v195
    v_cvt_pk_bf16_f32 v242, v196, v197
    v_mfma_f32_16x16x32_bf16 v[216:219], v[232:235], v[40:43], v[216:219]
    v_cvt_pk_bf16_f32 v243, v198, v199
    v_cvt_pk_bf16_f32 v244, v200, v201
    v_cvt_pk_bf16_f32 v245, v202, v203
    v_mfma_f32_16x16x32_bf16 v[220:223], v[232:235], v[44:47], v[220:223]
    ds_read_b64_tr_b16 v[230:231], v249 offset:28672
    v_mfma_f32_16x16x32_bf16 v[208:211], v[236:239], v[48:51], v[208:211]
    v_cvt_pk_bf16_f32 v246, v204, v205
    v_cvt_pk_bf16_f32 v247, v206, v207
    v_mfma_f32_16x16x32_bf16 v[212:215], v[236:239], v[52:55], v[212:215]
    ds_read_b64_tr_b16 v[232:233], v249 offset:17408
    v_mfma_f32_16x16x32_bf16 v[216:219], v[236:239], v[56:59], v[216:219]
    buffer_store_dwordx4 v[240:243], v251, s[20:23], s34 offen sc1
    v_mfma_f32_16x16x32_bf16 v[220:223], v[236:239], v[60:63], v[220:223]
    s_add_u32 m0, s29, 1024
    s_add_u32 s31, s31, 73728
    ds_read_b64_tr_b16 v[234:235], v249 offset:21504
    s_waitcnt lgkmcnt(4)
    v_mfma_f32_16x16x32_bf16 v[208:211], v[224:227], v[64:67], v[208:211]
    buffer_load_dwordx4 v248, s[12:15], s31 offen lds
    v_mfma_f32_16x16x32_bf16 v[212:215], v[224:227], v[68:71], v[212:215]
    ds_read_b64_tr_b16 v[236:237], v249 offset:25600
    v_mfma_f32_16x16x32_bf16 v[216:219], v[224:227], v[72:75], v[216:219]
    buffer_store_dwordx4 v[244:247], v251, s[20:23], s37 offen sc1
    v_mfma_f32_16x16x32_bf16 v[220:223], v[224:227], v[76:79], v[220:223]
    ds_read_b64_tr_b16 v[238:239], v249 offset:29696
    s_waitcnt lgkmcnt(4)
    v_mfma_f32_16x16x32_bf16 v[208:211], v[228:231], v[80:83], v[208:211]
    s_add_u32 s34, s34, 3145728
    s_add_u32 s37, s37, 3145728
    v_mfma_f32_16x16x32_bf16 v[212:215], v[228:231], v[84:87], v[212:215]
    s_waitcnt vmcnt(8) lgkmcnt(0)
    s_barrier
    ds_read_b64_tr_b16 v[224:225], v249 offset:32768
    v_mfma_f32_16x16x32_bf16 v[216:219], v[228:231], v[88:91], v[216:219]
    v_mfma_f32_16x16x32_bf16 v[220:223], v[228:231], v[92:95], v[220:223]
    s_add_u32 m0, s29, 16384
    s_add_u32 s31, s31, 73728
    ds_read_b64_tr_b16 v[226:227], v249 offset:36864
    v_mfma_f32_16x16x32_bf16 v[208:211], v[232:235], v[96:99], v[208:211]
    buffer_load_dwordx4 v248, s[12:15], s31 offen lds
    v_mfma_f32_16x16x32_bf16 v[212:215], v[232:235], v[100:103], v[212:215]
    ds_read_b64_tr_b16 v[228:229], v249 offset:40960
    v_mfma_f32_16x16x32_bf16 v[216:219], v[232:235], v[104:107], v[216:219]
    v_mfma_f32_16x16x32_bf16 v[220:223], v[232:235], v[108:111], v[220:223]
    ds_read_b64_tr_b16 v[230:231], v249 offset:45056
    v_mfma_f32_16x16x32_bf16 v[208:211], v[236:239], v[112:115], v[208:211]
    v_mfma_f32_16x16x32_bf16 v[212:215], v[236:239], v[116:119], v[212:215]
    ds_read_b64_tr_b16 v[232:233], v249 offset:33792
    v_mfma_f32_16x16x32_bf16 v[216:219], v[236:239], v[120:123], v[216:219]
    v_mfma_f32_16x16x32_bf16 v[220:223], v[236:239], v[124:127], v[220:223]
    s_add_u32 m0, s29, 17408
    s_add_u32 s31, s31, 73728
    ds_read_b64_tr_b16 v[234:235], v249 offset:37888
    s_waitcnt lgkmcnt(4)
    v_mfma_f32_16x16x32_bf16 v[208:211], v[224:227], v[128:131], v[208:211]
    buffer_load_dwordx4 v248, s[12:15], s31 offen lds
    v_mfma_f32_16x16x32_bf16 v[212:215], v[224:227], v[132:135], v[212:215]
    ds_read_b64_tr_b16 v[236:237], v249 offset:41984
    v_mfma_f32_16x16x32_bf16 v[216:219], v[224:227], v[136:139], v[216:219]
    v_mfma_f32_16x16x32_bf16 v[220:223], v[224:227], v[140:143], v[220:223]
    ds_read_b64_tr_b16 v[238:239], v249 offset:46080
    s_waitcnt lgkmcnt(4)
    v_mfma_f32_16x16x32_bf16 v[208:211], v[228:231], v[144:147], v[208:211]
    v_mfma_f32_16x16x32_bf16 v[212:215], v[228:231], v[148:151], v[212:215]
    s_waitcnt vmcnt(7) lgkmcnt(0)
    s_barrier
    ds_read_b64_tr_b16 v[224:225], v249 offset:49152
    v_mfma_f32_16x16x32_bf16 v[216:219], v[228:231], v[152:155], v[216:219]
    v_mfma_f32_16x16x32_bf16 v[220:223], v[228:231], v[156:159], v[220:223]
    s_add_u32 m0, s29, 32768
    s_sub_u32 s31, s31, 368512
    ds_read_b64_tr_b16 v[226:227], v249 offset:53248
    v_mfma_f32_16x16x32_bf16 v[208:211], v[232:235], v[160:163], v[208:211]
    buffer_load_dwordx4 v248, s[12:15], s31 offen lds
    v_mfma_f32_16x16x32_bf16 v[212:215], v[232:235], v[164:167], v[212:215]
    ds_read_b64_tr_b16 v[228:229], v249 offset:57344
    v_mfma_f32_16x16x32_bf16 v[216:219], v[232:235], v[168:171], v[216:219]
    v_mfma_f32_16x16x32_bf16 v[220:223], v[232:235], v[172:175], v[220:223]
    ds_read_b64_tr_b16 v[230:231], v249 offset:61440
    v_mfma_f32_16x16x32_bf16 v[208:211], v[236:239], v[176:179], v[208:211]
    v_mfma_f32_16x16x32_bf16 v[212:215], v[236:239], v[180:183], v[212:215]
    ds_read_b64_tr_b16 v[232:233], v249 offset:50176
    v_mfma_f32_16x16x32_bf16 v[216:219], v[236:239], v[184:187], v[216:219]
    v_mfma_f32_16x16x32_bf16 v[220:223], v[236:239], v[188:191], v[220:223]
    s_add_u32 m0, s29, 33792
    s_add_u32 s31, s31, 73728
    ds_read_b64_tr_b16 v[234:235], v249 offset:54272
    s_waitcnt lgkmcnt(4)
    v_mfma_f32_16x16x32_bf16 v[192:195], v[224:227], v[0:3], 0
    buffer_load_dwordx4 v248, s[12:15], s31 offen lds
    v_mfma_f32_16x16x32_bf16 v[196:199], v[224:227], v[4:7], 0
    ds_read_b64_tr_b16 v[236:237], v249 offset:58368
    v_mfma_f32_16x16x32_bf16 v[200:203], v[224:227], v[8:11], 0
    v_mfma_f32_16x16x32_bf16 v[204:207], v[224:227], v[12:15], 0
    ds_read_b64_tr_b16 v[238:239], v249 offset:62464
    s_waitcnt lgkmcnt(4)
    v_mfma_f32_16x16x32_bf16 v[192:195], v[228:231], v[16:19], v[192:195]
    v_mfma_f32_16x16x32_bf16 v[196:199], v[228:231], v[20:23], v[196:199]
    s_waitcnt vmcnt(4) lgkmcnt(0)
    s_barrier
    v_add_u32 v254, 1, v254
    buffer_store_dword v254, v253, s[20:23], s36 offen sc1
    ds_read_b64_tr_b16 v[224:225], v249 offset:0
    v_mfma_f32_16x16x32_bf16 v[200:203], v[228:231], v[24:27], v[200:203]
    v_mfma_f32_16x16x32_bf16 v[204:207], v[228:231], v[28:31], v[204:207]
    s_add_u32 m0, s29, 49152
    s_add_u32 s31, s31, 73728
    ds_read_b64_tr_b16 v[226:227], v249 offset:4096
    v_mfma_f32_16x16x32_bf16 v[192:195], v[232:235], v[32:35], v[192:195]
    buffer_load_dwordx4 v248, s[12:15], s31 offen lds
    v_mfma_f32_16x16x32_bf16 v[196:199], v[232:235], v[36:39], v[196:199]
    ds_read_b64_tr_b16 v[228:229], v249 offset:8192
    v_cvt_pk_bf16_f32 v240, v208, v209
    v_cvt_pk_bf16_f32 v241, v210, v211
    v_cvt_pk_bf16_f32 v242, v212, v213
    v_mfma_f32_16x16x32_bf16 v[200:203], v[232:235], v[40:43], v[200:203]
    v_cvt_pk_bf16_f32 v243, v214, v215
    v_cvt_pk_bf16_f32 v244, v216, v217
    v_cvt_pk_bf16_f32 v245, v218, v219
    v_mfma_f32_16x16x32_bf16 v[204:207], v[232:235], v[44:47], v[204:207]
    ds_read_b64_tr_b16 v[230:231], v249 offset:12288
    v_mfma_f32_16x16x32_bf16 v[192:195], v[236:239], v[48:51], v[192:195]
    v_cvt_pk_bf16_f32 v246, v220, v221
    v_cvt_pk_bf16_f32 v247, v222, v223
    v_mfma_f32_16x16x32_bf16 v[196:199], v[236:239], v[52:55], v[196:199]
    ds_read_b64_tr_b16 v[232:233], v249 offset:1024
    v_mfma_f32_16x16x32_bf16 v[200:203], v[236:239], v[56:59], v[200:203]
    buffer_store_dwordx4 v[240:243], v251, s[20:23], s34 offen sc1
    v_mfma_f32_16x16x32_bf16 v[204:207], v[236:239], v[60:63], v[204:207]
    s_add_u32 m0, s29, 50176
    s_add_u32 s31, s31, 73728
    ds_read_b64_tr_b16 v[234:235], v249 offset:5120
    s_waitcnt lgkmcnt(4)
    v_mfma_f32_16x16x32_bf16 v[192:195], v[224:227], v[64:67], v[192:195]
    buffer_load_dwordx4 v248, s[12:15], s31 offen lds
    v_mfma_f32_16x16x32_bf16 v[196:199], v[224:227], v[68:71], v[196:199]
    ds_read_b64_tr_b16 v[236:237], v249 offset:9216
    v_mfma_f32_16x16x32_bf16 v[200:203], v[224:227], v[72:75], v[200:203]
    buffer_store_dwordx4 v[244:247], v251, s[20:23], s37 offen sc1
    v_mfma_f32_16x16x32_bf16 v[204:207], v[224:227], v[76:79], v[204:207]
    ds_read_b64_tr_b16 v[238:239], v249 offset:13312
    s_waitcnt lgkmcnt(4)
    v_mfma_f32_16x16x32_bf16 v[192:195], v[228:231], v[80:83], v[192:195]
    s_add_u32 s34, s34, 3145728
    s_add_u32 s37, s37, 3145728
    v_mfma_f32_16x16x32_bf16 v[196:199], v[228:231], v[84:87], v[196:199]
    s_waitcnt vmcnt(7) lgkmcnt(0)
    s_barrier
    ds_read_b64_tr_b16 v[224:225], v249 offset:16384
    v_mfma_f32_16x16x32_bf16 v[200:203], v[228:231], v[88:91], v[200:203]
    v_mfma_f32_16x16x32_bf16 v[204:207], v[228:231], v[92:95], v[204:207]
    s_add_u32 m0, s29, 0
    s_add_u32 s31, s31, 73728
    ds_read_b64_tr_b16 v[226:227], v249 offset:20480
    v_mfma_f32_16x16x32_bf16 v[192:195], v[232:235], v[96:99], v[192:195]
    buffer_load_dwordx4 v248, s[12:15], s31 offen lds
    v_mfma_f32_16x16x32_bf16 v[196:199], v[232:235], v[100:103], v[196:199]
    ds_read_b64_tr_b16 v[228:229], v249 offset:24576
    v_mfma_f32_16x16x32_bf16 v[200:203], v[232:235], v[104:107], v[200:203]
    v_mfma_f32_16x16x32_bf16 v[204:207], v[232:235], v[108:111], v[204:207]
    ds_read_b64_tr_b16 v[230:231], v249 offset:28672
    v_mfma_f32_16x16x32_bf16 v[192:195], v[236:239], v[112:115], v[192:195]
    v_mfma_f32_16x16x32_bf16 v[196:199], v[236:239], v[116:119], v[196:199]
    ds_read_b64_tr_b16 v[232:233], v249 offset:17408
    v_mfma_f32_16x16x32_bf16 v[200:203], v[236:239], v[120:123], v[200:203]
    v_mfma_f32_16x16x32_bf16 v[204:207], v[236:239], v[124:127], v[204:207]
    s_add_u32 m0, s29, 1024
    s_add_u32 s31, s31, 73728
    ds_read_b64_tr_b16 v[234:235], v249 offset:21504
    s_waitcnt lgkmcnt(4)
    v_mfma_f32_16x16x32_bf16 v[192:195], v[224:227], v[128:131], v[192:195]
    buffer_load_dwordx4 v248, s[12:15], s31 offen lds
    v_mfma_f32_16x16x32_bf16 v[196:199], v[224:227], v[132:135], v[196:199]
    ds_read_b64_tr_b16 v[236:237], v249 offset:25600
    v_mfma_f32_16x16x32_bf16 v[200:203], v[224:227], v[136:139], v[200:203]
    v_mfma_f32_16x16x32_bf16 v[204:207], v[224:227], v[140:143], v[204:207]
    ds_read_b64_tr_b16 v[238:239], v249 offset:29696
    s_waitcnt lgkmcnt(4)
    v_mfma_f32_16x16x32_bf16 v[192:195], v[228:231], v[144:147], v[192:195]
    v_mfma_f32_16x16x32_bf16 v[196:199], v[228:231], v[148:151], v[196:199]
    s_waitcnt vmcnt(7) lgkmcnt(0)
    s_barrier
    ds_read_b64_tr_b16 v[224:225], v249 offset:32768
    v_mfma_f32_16x16x32_bf16 v[200:203], v[228:231], v[152:155], v[200:203]
    v_mfma_f32_16x16x32_bf16 v[204:207], v[228:231], v[156:159], v[204:207]
    s_add_u32 m0, s29, 16384
    s_sub_u32 s31, s31, 368512
    ds_read_b64_tr_b16 v[226:227], v249 offset:36864
    v_mfma_f32_16x16x32_bf16 v[192:195], v[232:235], v[160:163], v[192:195]
    buffer_load_dwordx4 v248, s[12:15], s31 offen lds
    v_mfma_f32_16x16x32_bf16 v[196:199], v[232:235], v[164:167], v[196:199]
    ds_read_b64_tr_b16 v[228:229], v249 offset:40960
    v_mfma_f32_16x16x32_bf16 v[200:203], v[232:235], v[168:171], v[200:203]
    v_mfma_f32_16x16x32_bf16 v[204:207], v[232:235], v[172:175], v[204:207]
    ds_read_b64_tr_b16 v[230:231], v249 offset:45056
    v_mfma_f32_16x16x32_bf16 v[192:195], v[236:239], v[176:179], v[192:195]
    v_mfma_f32_16x16x32_bf16 v[196:199], v[236:239], v[180:183], v[196:199]
    ds_read_b64_tr_b16 v[232:233], v249 offset:33792
    v_mfma_f32_16x16x32_bf16 v[200:203], v[236:239], v[184:187], v[200:203]
    v_mfma_f32_16x16x32_bf16 v[204:207], v[236:239], v[188:191], v[204:207]
    s_add_u32 m0, s29, 17408
    s_add_u32 s31, s31, 73728
    ds_read_b64_tr_b16 v[234:235], v249 offset:37888
    s_waitcnt lgkmcnt(4)
    v_mfma_f32_16x16x32_bf16 v[208:211], v[224:227], v[0:3], 0
    buffer_load_dwordx4 v248, s[12:15], s31 offen lds
    v_mfma_f32_16x16x32_bf16 v[212:215], v[224:227], v[4:7], 0
    ds_read_b64_tr_b16 v[236:237], v249 offset:41984
    v_mfma_f32_16x16x32_bf16 v[216:219], v[224:227], v[8:11], 0
    v_mfma_f32_16x16x32_bf16 v[220:223], v[224:227], v[12:15], 0
    ds_read_b64_tr_b16 v[238:239], v249 offset:46080
    s_waitcnt lgkmcnt(4)
    v_mfma_f32_16x16x32_bf16 v[208:211], v[228:231], v[16:19], v[208:211]
    v_mfma_f32_16x16x32_bf16 v[212:215], v[228:231], v[20:23], v[212:215]
    s_waitcnt vmcnt(4) lgkmcnt(0)
    s_barrier
    v_add_u32 v254, 1, v254
    buffer_store_dword v254, v253, s[20:23], s36 offen sc1
    ds_read_b64_tr_b16 v[224:225], v249 offset:49152
    v_mfma_f32_16x16x32_bf16 v[216:219], v[228:231], v[24:27], v[216:219]
    v_mfma_f32_16x16x32_bf16 v[220:223], v[228:231], v[28:31], v[220:223]
    s_add_u32 m0, s29, 32768
    s_add_u32 s31, s31, 73728
    ds_read_b64_tr_b16 v[226:227], v249 offset:53248
    v_mfma_f32_16x16x32_bf16 v[208:211], v[232:235], v[32:35], v[208:211]
    buffer_load_dwordx4 v248, s[12:15], s31 offen lds
    v_mfma_f32_16x16x32_bf16 v[212:215], v[232:235], v[36:39], v[212:215]
    ds_read_b64_tr_b16 v[228:229], v249 offset:57344
    v_cvt_pk_bf16_f32 v240, v192, v193
    v_cvt_pk_bf16_f32 v241, v194, v195
    v_cvt_pk_bf16_f32 v242, v196, v197
    v_mfma_f32_16x16x32_bf16 v[216:219], v[232:235], v[40:43], v[216:219]
    v_cvt_pk_bf16_f32 v243, v198, v199
    v_cvt_pk_bf16_f32 v244, v200, v201
    v_cvt_pk_bf16_f32 v245, v202, v203
    v_mfma_f32_16x16x32_bf16 v[220:223], v[232:235], v[44:47], v[220:223]
    ds_read_b64_tr_b16 v[230:231], v249 offset:61440
    v_mfma_f32_16x16x32_bf16 v[208:211], v[236:239], v[48:51], v[208:211]
    v_cvt_pk_bf16_f32 v246, v204, v205
    v_cvt_pk_bf16_f32 v247, v206, v207
    v_mfma_f32_16x16x32_bf16 v[212:215], v[236:239], v[52:55], v[212:215]
    ds_read_b64_tr_b16 v[232:233], v249 offset:50176
    v_mfma_f32_16x16x32_bf16 v[216:219], v[236:239], v[56:59], v[216:219]
    buffer_store_dwordx4 v[240:243], v251, s[20:23], s34 offen sc1
    v_mfma_f32_16x16x32_bf16 v[220:223], v[236:239], v[60:63], v[220:223]
    s_add_u32 m0, s29, 33792
    s_add_u32 s31, s31, 73728
    ds_read_b64_tr_b16 v[234:235], v249 offset:54272
    s_waitcnt lgkmcnt(4)
    v_mfma_f32_16x16x32_bf16 v[208:211], v[224:227], v[64:67], v[208:211]
    buffer_load_dwordx4 v248, s[12:15], s31 offen lds
    v_mfma_f32_16x16x32_bf16 v[212:215], v[224:227], v[68:71], v[212:215]
    ds_read_b64_tr_b16 v[236:237], v249 offset:58368
    v_mfma_f32_16x16x32_bf16 v[216:219], v[224:227], v[72:75], v[216:219]
    buffer_store_dwordx4 v[244:247], v251, s[20:23], s37 offen sc1
    v_mfma_f32_16x16x32_bf16 v[220:223], v[224:227], v[76:79], v[220:223]
    ds_read_b64_tr_b16 v[238:239], v249 offset:62464
    s_waitcnt lgkmcnt(4)
    v_mfma_f32_16x16x32_bf16 v[208:211], v[228:231], v[80:83], v[208:211]
    s_add_u32 s34, s34, 3145728
    s_add_u32 s37, s37, 3145728
    v_mfma_f32_16x16x32_bf16 v[212:215], v[228:231], v[84:87], v[212:215]
    s_waitcnt vmcnt(7) lgkmcnt(0)
    s_barrier
    ds_read_b64_tr_b16 v[224:225], v249 offset:0
    v_mfma_f32_16x16x32_bf16 v[216:219], v[228:231], v[88:91], v[216:219]
    v_mfma_f32_16x16x32_bf16 v[220:223], v[228:231], v[92:95], v[220:223]
    s_add_u32 m0, s29, 49152
    s_add_u32 s31, s31, 73728
    ds_read_b64_tr_b16 v[226:227], v249 offset:4096
    v_mfma_f32_16x16x32_bf16 v[208:211], v[232:235], v[96:99], v[208:211]
    buffer_load_dwordx4 v248, s[12:15], s31 offen lds
    v_mfma_f32_16x16x32_bf16 v[212:215], v[232:235], v[100:103], v[212:215]
    ds_read_b64_tr_b16 v[228:229], v249 offset:8192
    v_mfma_f32_16x16x32_bf16 v[216:219], v[232:235], v[104:107], v[216:219]
    v_mfma_f32_16x16x32_bf16 v[220:223], v[232:235], v[108:111], v[220:223]
    ds_read_b64_tr_b16 v[230:231], v249 offset:12288
    v_mfma_f32_16x16x32_bf16 v[208:211], v[236:239], v[112:115], v[208:211]
    v_mfma_f32_16x16x32_bf16 v[212:215], v[236:239], v[116:119], v[212:215]
    ds_read_b64_tr_b16 v[232:233], v249 offset:1024
    v_mfma_f32_16x16x32_bf16 v[216:219], v[236:239], v[120:123], v[216:219]
    v_mfma_f32_16x16x32_bf16 v[220:223], v[236:239], v[124:127], v[220:223]
    s_add_u32 m0, s29, 50176
    s_add_u32 s31, s31, 73728
    ds_read_b64_tr_b16 v[234:235], v249 offset:5120
    s_waitcnt lgkmcnt(4)
    v_mfma_f32_16x16x32_bf16 v[208:211], v[224:227], v[128:131], v[208:211]
    buffer_load_dwordx4 v248, s[12:15], s31 offen lds
    v_mfma_f32_16x16x32_bf16 v[212:215], v[224:227], v[132:135], v[212:215]
    ds_read_b64_tr_b16 v[236:237], v249 offset:9216
    v_mfma_f32_16x16x32_bf16 v[216:219], v[224:227], v[136:139], v[216:219]
    v_mfma_f32_16x16x32_bf16 v[220:223], v[224:227], v[140:143], v[220:223]
    ds_read_b64_tr_b16 v[238:239], v249 offset:13312
    s_waitcnt lgkmcnt(4)
    v_mfma_f32_16x16x32_bf16 v[208:211], v[228:231], v[144:147], v[208:211]
    v_mfma_f32_16x16x32_bf16 v[212:215], v[228:231], v[148:151], v[212:215]
    s_waitcnt vmcnt(7) lgkmcnt(0)
    s_barrier
    ds_read_b64_tr_b16 v[224:225], v249 offset:16384
    v_mfma_f32_16x16x32_bf16 v[216:219], v[228:231], v[152:155], v[216:219]
    v_mfma_f32_16x16x32_bf16 v[220:223], v[228:231], v[156:159], v[220:223]
    s_add_u32 m0, s29, 0
    s_sub_u32 s31, s31, 368512
    ds_read_b64_tr_b16 v[226:227], v249 offset:20480
    v_mfma_f32_16x16x32_bf16 v[208:211], v[232:235], v[160:163], v[208:211]
    buffer_load_dwordx4 v248, s[12:15], s31 offen lds
    v_mfma_f32_16x16x32_bf16 v[212:215], v[232:235], v[164:167], v[212:215]
    ds_read_b64_tr_b16 v[228:229], v249 offset:24576
    v_mfma_f32_16x16x32_bf16 v[216:219], v[232:235], v[168:171], v[216:219]
    v_mfma_f32_16x16x32_bf16 v[220:223], v[232:235], v[172:175], v[220:223]
    ds_read_b64_tr_b16 v[230:231], v249 offset:28672
    v_mfma_f32_16x16x32_bf16 v[208:211], v[236:239], v[176:179], v[208:211]
    v_mfma_f32_16x16x32_bf16 v[212:215], v[236:239], v[180:183], v[212:215]
    ds_read_b64_tr_b16 v[232:233], v249 offset:17408
    v_mfma_f32_16x16x32_bf16 v[216:219], v[236:239], v[184:187], v[216:219]
    v_mfma_f32_16x16x32_bf16 v[220:223], v[236:239], v[188:191], v[220:223]
    s_add_u32 m0, s29, 1024
    s_add_u32 s31, s31, 73728
    ds_read_b64_tr_b16 v[234:235], v249 offset:21504
    s_waitcnt lgkmcnt(4)
    v_mfma_f32_16x16x32_bf16 v[192:195], v[224:227], v[0:3], 0
    buffer_load_dwordx4 v248, s[12:15], s31 offen lds
    v_mfma_f32_16x16x32_bf16 v[196:199], v[224:227], v[4:7], 0
    ds_read_b64_tr_b16 v[236:237], v249 offset:25600
    v_mfma_f32_16x16x32_bf16 v[200:203], v[224:227], v[8:11], 0
    v_mfma_f32_16x16x32_bf16 v[204:207], v[224:227], v[12:15], 0
    ds_read_b64_tr_b16 v[238:239], v249 offset:29696
    s_waitcnt lgkmcnt(4)
    v_mfma_f32_16x16x32_bf16 v[192:195], v[228:231], v[16:19], v[192:195]
    v_mfma_f32_16x16x32_bf16 v[196:199], v[228:231], v[20:23], v[196:199]
    s_waitcnt vmcnt(4) lgkmcnt(0)
    s_barrier
    v_add_u32 v254, 1, v254
    buffer_store_dword v254, v253, s[20:23], s36 offen sc1
    ds_read_b64_tr_b16 v[224:225], v249 offset:32768
    v_mfma_f32_16x16x32_bf16 v[200:203], v[228:231], v[24:27], v[200:203]
    v_mfma_f32_16x16x32_bf16 v[204:207], v[228:231], v[28:31], v[204:207]
    s_add_u32 m0, s29, 16384
    s_add_u32 s31, s31, 73728
    ds_read_b64_tr_b16 v[226:227], v249 offset:36864
    v_mfma_f32_16x16x32_bf16 v[192:195], v[232:235], v[32:35], v[192:195]
    buffer_load_dwordx4 v248, s[12:15], s31 offen lds
    v_mfma_f32_16x16x32_bf16 v[196:199], v[232:235], v[36:39], v[196:199]
    ds_read_b64_tr_b16 v[228:229], v249 offset:40960
    v_cvt_pk_bf16_f32 v240, v208, v209
    v_cvt_pk_bf16_f32 v241, v210, v211
    v_cvt_pk_bf16_f32 v242, v212, v213
    v_mfma_f32_16x16x32_bf16 v[200:203], v[232:235], v[40:43], v[200:203]
    v_cvt_pk_bf16_f32 v243, v214, v215
    v_cvt_pk_bf16_f32 v244, v216, v217
    v_cvt_pk_bf16_f32 v245, v218, v219
    v_mfma_f32_16x16x32_bf16 v[204:207], v[232:235], v[44:47], v[204:207]
    ds_read_b64_tr_b16 v[230:231], v249 offset:45056
    v_mfma_f32_16x16x32_bf16 v[192:195], v[236:239], v[48:51], v[192:195]
    v_cvt_pk_bf16_f32 v246, v220, v221
    v_cvt_pk_bf16_f32 v247, v222, v223
    v_mfma_f32_16x16x32_bf16 v[196:199], v[236:239], v[52:55], v[196:199]
    ds_read_b64_tr_b16 v[232:233], v249 offset:33792
    v_mfma_f32_16x16x32_bf16 v[200:203], v[236:239], v[56:59], v[200:203]
    buffer_store_dwordx4 v[240:243], v251, s[20:23], s34 offen sc1
    v_mfma_f32_16x16x32_bf16 v[204:207], v[236:239], v[60:63], v[204:207]
    s_add_u32 m0, s29, 17408
    s_add_u32 s31, s31, 73728
    ds_read_b64_tr_b16 v[234:235], v249 offset:37888
    s_waitcnt lgkmcnt(4)
    v_mfma_f32_16x16x32_bf16 v[192:195], v[224:227], v[64:67], v[192:195]
    buffer_load_dwordx4 v248, s[12:15], s31 offen lds
    v_mfma_f32_16x16x32_bf16 v[196:199], v[224:227], v[68:71], v[196:199]
    ds_read_b64_tr_b16 v[236:237], v249 offset:41984
    v_mfma_f32_16x16x32_bf16 v[200:203], v[224:227], v[72:75], v[200:203]
    buffer_store_dwordx4 v[244:247], v251, s[20:23], s37 offen sc1
    v_mfma_f32_16x16x32_bf16 v[204:207], v[224:227], v[76:79], v[204:207]
    ds_read_b64_tr_b16 v[238:239], v249 offset:46080
    s_waitcnt lgkmcnt(4)
    v_mfma_f32_16x16x32_bf16 v[192:195], v[228:231], v[80:83], v[192:195]
    s_add_u32 s34, s34, 3145728
    s_add_u32 s37, s37, 3145728
    v_mfma_f32_16x16x32_bf16 v[196:199], v[228:231], v[84:87], v[196:199]
    s_waitcnt vmcnt(7) lgkmcnt(0)
    s_barrier
    ds_read_b64_tr_b16 v[224:225], v249 offset:49152
    v_mfma_f32_16x16x32_bf16 v[200:203], v[228:231], v[88:91], v[200:203]
    v_mfma_f32_16x16x32_bf16 v[204:207], v[228:231], v[92:95], v[204:207]
    s_add_u32 m0, s29, 32768
    s_add_u32 s31, s31, 73728
    ds_read_b64_tr_b16 v[226:227], v249 offset:53248
    v_mfma_f32_16x16x32_bf16 v[192:195], v[232:235], v[96:99], v[192:195]
    buffer_load_dwordx4 v248, s[12:15], s31 offen lds
    v_mfma_f32_16x16x32_bf16 v[196:199], v[232:235], v[100:103], v[196:199]
    ds_read_b64_tr_b16 v[228:229], v249 offset:57344
    v_mfma_f32_16x16x32_bf16 v[200:203], v[232:235], v[104:107], v[200:203]
    v_mfma_f32_16x16x32_bf16 v[204:207], v[232:235], v[108:111], v[204:207]
    ds_read_b64_tr_b16 v[230:231], v249 offset:61440
    v_mfma_f32_16x16x32_bf16 v[192:195], v[236:239], v[112:115], v[192:195]
    v_mfma_f32_16x16x32_bf16 v[196:199], v[236:239], v[116:119], v[196:199]
    ds_read_b64_tr_b16 v[232:233], v249 offset:50176
    v_mfma_f32_16x16x32_bf16 v[200:203], v[236:239], v[120:123], v[200:203]
    v_mfma_f32_16x16x32_bf16 v[204:207], v[236:239], v[124:127], v[204:207]
    s_add_u32 m0, s29, 33792
    s_add_u32 s31, s31, 73728
    ds_read_b64_tr_b16 v[234:235], v249 offset:54272
    s_waitcnt lgkmcnt(4)
    v_mfma_f32_16x16x32_bf16 v[192:195], v[224:227], v[128:131], v[192:195]
    buffer_load_dwordx4 v248, s[12:15], s31 offen lds
    v_mfma_f32_16x16x32_bf16 v[196:199], v[224:227], v[132:135], v[196:199]
    ds_read_b64_tr_b16 v[236:237], v249 offset:58368
    v_mfma_f32_16x16x32_bf16 v[200:203], v[224:227], v[136:139], v[200:203]
    v_mfma_f32_16x16x32_bf16 v[204:207], v[224:227], v[140:143], v[204:207]
    ds_read_b64_tr_b16 v[238:239], v249 offset:62464
    s_waitcnt lgkmcnt(4)
    v_mfma_f32_16x16x32_bf16 v[192:195], v[228:231], v[144:147], v[192:195]
    v_mfma_f32_16x16x32_bf16 v[196:199], v[228:231], v[148:151], v[196:199]
    s_waitcnt vmcnt(7) lgkmcnt(0)
    s_barrier
    ds_read_b64_tr_b16 v[224:225], v249 offset:0
    v_mfma_f32_16x16x32_bf16 v[200:203], v[228:231], v[152:155], v[200:203]
    v_mfma_f32_16x16x32_bf16 v[204:207], v[228:231], v[156:159], v[204:207]
    s_add_u32 m0, s29, 49152
    s_sub_u32 s31, s31, 368512
    ds_read_b64_tr_b16 v[226:227], v249 offset:4096
    v_mfma_f32_16x16x32_bf16 v[192:195], v[232:235], v[160:163], v[192:195]
    buffer_load_dwordx4 v248, s[12:15], s31 offen lds
    v_mfma_f32_16x16x32_bf16 v[196:199], v[232:235], v[164:167], v[196:199]
    ds_read_b64_tr_b16 v[228:229], v249 offset:8192
    v_mfma_f32_16x16x32_bf16 v[200:203], v[232:235], v[168:171], v[200:203]
    v_mfma_f32_16x16x32_bf16 v[204:207], v[232:235], v[172:175], v[204:207]
    ds_read_b64_tr_b16 v[230:231], v249 offset:12288
    v_mfma_f32_16x16x32_bf16 v[192:195], v[236:239], v[176:179], v[192:195]
    v_mfma_f32_16x16x32_bf16 v[196:199], v[236:239], v[180:183], v[196:199]
    ds_read_b64_tr_b16 v[232:233], v249 offset:1024
    v_mfma_f32_16x16x32_bf16 v[200:203], v[236:239], v[184:187], v[200:203]
    v_mfma_f32_16x16x32_bf16 v[204:207], v[236:239], v[188:191], v[204:207]
    s_add_u32 m0, s29, 50176
    s_add_u32 s31, s31, 73728
    ds_read_b64_tr_b16 v[234:235], v249 offset:5120
    s_waitcnt lgkmcnt(4)
    v_mfma_f32_16x16x32_bf16 v[208:211], v[224:227], v[0:3], 0
    buffer_load_dwordx4 v248, s[12:15], s31 offen lds
    v_mfma_f32_16x16x32_bf16 v[212:215], v[224:227], v[4:7], 0
    ds_read_b64_tr_b16 v[236:237], v249 offset:9216
    v_mfma_f32_16x16x32_bf16 v[216:219], v[224:227], v[8:11], 0
    v_mfma_f32_16x16x32_bf16 v[220:223], v[224:227], v[12:15], 0
    ds_read_b64_tr_b16 v[238:239], v249 offset:13312
    s_waitcnt lgkmcnt(4)
    v_mfma_f32_16x16x32_bf16 v[208:211], v[228:231], v[16:19], v[208:211]
    v_mfma_f32_16x16x32_bf16 v[212:215], v[228:231], v[20:23], v[212:215]
    s_waitcnt vmcnt(4) lgkmcnt(0)
    s_barrier
    v_add_u32 v254, 1, v254
    buffer_store_dword v254, v253, s[20:23], s36 offen sc1
    ds_read_b64_tr_b16 v[224:225], v249 offset:16384
    v_mfma_f32_16x16x32_bf16 v[216:219], v[228:231], v[24:27], v[216:219]
    v_mfma_f32_16x16x32_bf16 v[220:223], v[228:231], v[28:31], v[220:223]
    s_add_u32 m0, s29, 0
    s_add_u32 s31, s31, 73728
    ds_read_b64_tr_b16 v[226:227], v249 offset:20480
    v_mfma_f32_16x16x32_bf16 v[208:211], v[232:235], v[32:35], v[208:211]
    buffer_load_dwordx4 v248, s[12:15], s31 offen lds
    v_mfma_f32_16x16x32_bf16 v[212:215], v[232:235], v[36:39], v[212:215]
    ds_read_b64_tr_b16 v[228:229], v249 offset:24576
    v_cvt_pk_bf16_f32 v240, v192, v193
    v_cvt_pk_bf16_f32 v241, v194, v195
    v_cvt_pk_bf16_f32 v242, v196, v197
    v_mfma_f32_16x16x32_bf16 v[216:219], v[232:235], v[40:43], v[216:219]
    v_cvt_pk_bf16_f32 v243, v198, v199
    v_cvt_pk_bf16_f32 v244, v200, v201
    v_cvt_pk_bf16_f32 v245, v202, v203
    v_mfma_f32_16x16x32_bf16 v[220:223], v[232:235], v[44:47], v[220:223]
    ds_read_b64_tr_b16 v[230:231], v249 offset:28672
    v_mfma_f32_16x16x32_bf16 v[208:211], v[236:239], v[48:51], v[208:211]
    v_cvt_pk_bf16_f32 v246, v204, v205
    v_cvt_pk_bf16_f32 v247, v206, v207
    v_mfma_f32_16x16x32_bf16 v[212:215], v[236:239], v[52:55], v[212:215]
    ds_read_b64_tr_b16 v[232:233], v249 offset:17408
    v_mfma_f32_16x16x32_bf16 v[216:219], v[236:239], v[56:59], v[216:219]
    buffer_store_dwordx4 v[240:243], v251, s[20:23], s34 offen sc1
    v_mfma_f32_16x16x32_bf16 v[220:223], v[236:239], v[60:63], v[220:223]
    s_add_u32 m0, s29, 1024
    s_add_u32 s31, s31, 73728
    ds_read_b64_tr_b16 v[234:235], v249 offset:21504
    s_waitcnt lgkmcnt(4)
    v_mfma_f32_16x16x32_bf16 v[208:211], v[224:227], v[64:67], v[208:211]
    buffer_load_dwordx4 v248, s[12:15], s31 offen lds
    v_mfma_f32_16x16x32_bf16 v[212:215], v[224:227], v[68:71], v[212:215]
    ds_read_b64_tr_b16 v[236:237], v249 offset:25600
    v_mfma_f32_16x16x32_bf16 v[216:219], v[224:227], v[72:75], v[216:219]
    buffer_store_dwordx4 v[244:247], v251, s[20:23], s37 offen sc1
    v_mfma_f32_16x16x32_bf16 v[220:223], v[224:227], v[76:79], v[220:223]
    ds_read_b64_tr_b16 v[238:239], v249 offset:29696
    s_waitcnt lgkmcnt(4)
    v_mfma_f32_16x16x32_bf16 v[208:211], v[228:231], v[80:83], v[208:211]
    s_add_u32 s34, s34, 3145728
    s_add_u32 s37, s37, 3145728
    v_mfma_f32_16x16x32_bf16 v[212:215], v[228:231], v[84:87], v[212:215]
    s_waitcnt vmcnt(7) lgkmcnt(0)
    s_barrier
    ds_read_b64_tr_b16 v[224:225], v249 offset:32768
    v_mfma_f32_16x16x32_bf16 v[216:219], v[228:231], v[88:91], v[216:219]
    v_mfma_f32_16x16x32_bf16 v[220:223], v[228:231], v[92:95], v[220:223]
    s_add_u32 m0, s29, 16384
    s_add_u32 s31, s31, 73728
    ds_read_b64_tr_b16 v[226:227], v249 offset:36864
    v_mfma_f32_16x16x32_bf16 v[208:211], v[232:235], v[96:99], v[208:211]
    buffer_load_dwordx4 v248, s[12:15], s31 offen lds
    v_mfma_f32_16x16x32_bf16 v[212:215], v[232:235], v[100:103], v[212:215]
    ds_read_b64_tr_b16 v[228:229], v249 offset:40960
    v_mfma_f32_16x16x32_bf16 v[216:219], v[232:235], v[104:107], v[216:219]
    v_mfma_f32_16x16x32_bf16 v[220:223], v[232:235], v[108:111], v[220:223]
    ds_read_b64_tr_b16 v[230:231], v249 offset:45056
    v_mfma_f32_16x16x32_bf16 v[208:211], v[236:239], v[112:115], v[208:211]
    v_mfma_f32_16x16x32_bf16 v[212:215], v[236:239], v[116:119], v[212:215]
    ds_read_b64_tr_b16 v[232:233], v249 offset:33792
    v_mfma_f32_16x16x32_bf16 v[216:219], v[236:239], v[120:123], v[216:219]
    v_mfma_f32_16x16x32_bf16 v[220:223], v[236:239], v[124:127], v[220:223]
    s_add_u32 m0, s29, 17408
    s_add_u32 s31, s31, 73728
    ds_read_b64_tr_b16 v[234:235], v249 offset:37888
    s_waitcnt lgkmcnt(4)
    v_mfma_f32_16x16x32_bf16 v[208:211], v[224:227], v[128:131], v[208:211]
    buffer_load_dwordx4 v248, s[12:15], s31 offen lds
    v_mfma_f32_16x16x32_bf16 v[212:215], v[224:227], v[132:135], v[212:215]
    ds_read_b64_tr_b16 v[236:237], v249 offset:41984
    v_mfma_f32_16x16x32_bf16 v[216:219], v[224:227], v[136:139], v[216:219]
    v_mfma_f32_16x16x32_bf16 v[220:223], v[224:227], v[140:143], v[220:223]
    ds_read_b64_tr_b16 v[238:239], v249 offset:46080
    s_waitcnt lgkmcnt(4)
    v_mfma_f32_16x16x32_bf16 v[208:211], v[228:231], v[144:147], v[208:211]
    v_mfma_f32_16x16x32_bf16 v[212:215], v[228:231], v[148:151], v[212:215]
    s_waitcnt vmcnt(7) lgkmcnt(0)
    s_barrier
    ds_read_b64_tr_b16 v[224:225], v249 offset:49152
    v_mfma_f32_16x16x32_bf16 v[216:219], v[228:231], v[152:155], v[216:219]
    v_mfma_f32_16x16x32_bf16 v[220:223], v[228:231], v[156:159], v[220:223]
    ds_read_b64_tr_b16 v[226:227], v249 offset:53248
    v_mfma_f32_16x16x32_bf16 v[208:211], v[232:235], v[160:163], v[208:211]
    v_mfma_f32_16x16x32_bf16 v[212:215], v[232:235], v[164:167], v[212:215]
    ds_read_b64_tr_b16 v[228:229], v249 offset:57344
    v_mfma_f32_16x16x32_bf16 v[216:219], v[232:235], v[168:171], v[216:219]
    v_mfma_f32_16x16x32_bf16 v[220:223], v[232:235], v[172:175], v[220:223]
    ds_read_b64_tr_b16 v[230:231], v249 offset:61440
    v_mfma_f32_16x16x32_bf16 v[208:211], v[236:239], v[176:179], v[208:211]
    v_mfma_f32_16x16x32_bf16 v[212:215], v[236:239], v[180:183], v[212:215]
    ds_read_b64_tr_b16 v[232:233], v249 offset:50176
    v_mfma_f32_16x16x32_bf16 v[216:219], v[236:239], v[184:187], v[216:219]
    v_mfma_f32_16x16x32_bf16 v[220:223], v[236:239], v[188:191], v[220:223]
    ds_read_b64_tr_b16 v[234:235], v249 offset:54272
    s_waitcnt lgkmcnt(4)
    v_mfma_f32_16x16x32_bf16 v[192:195], v[224:227], v[0:3], 0
    v_mfma_f32_16x16x32_bf16 v[196:199], v[224:227], v[4:7], 0
    ds_read_b64_tr_b16 v[236:237], v249 offset:58368
    v_mfma_f32_16x16x32_bf16 v[200:203], v[224:227], v[8:11], 0
    v_mfma_f32_16x16x32_bf16 v[204:207], v[224:227], v[12:15], 0
    ds_read_b64_tr_b16 v[238:239], v249 offset:62464
    s_waitcnt lgkmcnt(4)
    v_mfma_f32_16x16x32_bf16 v[192:195], v[228:231], v[16:19], v[192:195]
    v_mfma_f32_16x16x32_bf16 v[196:199], v[228:231], v[20:23], v[196:199]
    s_waitcnt vmcnt(2) lgkmcnt(0)
    s_barrier
    v_add_u32 v254, 1, v254
    buffer_store_dword v254, v253, s[20:23], s36 offen sc1
    ds_read_b64_tr_b16 v[224:225], v249 offset:0
    v_mfma_f32_16x16x32_bf16 v[200:203], v[228:231], v[24:27], v[200:203]
    v_mfma_f32_16x16x32_bf16 v[204:207], v[228:231], v[28:31], v[204:207]
    ds_read_b64_tr_b16 v[226:227], v249 offset:4096
    v_cvt_pk_bf16_f32 v240, v208, v209
    v_cvt_pk_bf16_f32 v241, v210, v211
    v_cvt_pk_bf16_f32 v242, v212, v213
    v_mfma_f32_16x16x32_bf16 v[192:195], v[232:235], v[32:35], v[192:195]
    v_cvt_pk_bf16_f32 v243, v214, v215
    v_cvt_pk_bf16_f32 v244, v216, v217
    v_cvt_pk_bf16_f32 v245, v218, v219
    v_mfma_f32_16x16x32_bf16 v[196:199], v[232:235], v[36:39], v[196:199]
    ds_read_b64_tr_b16 v[228:229], v249 offset:8192
    v_mfma_f32_16x16x32_bf16 v[200:203], v[232:235], v[40:43], v[200:203]
    v_cvt_pk_bf16_f32 v246, v220, v221
    v_cvt_pk_bf16_f32 v247, v222, v223
    v_mfma_f32_16x16x32_bf16 v[204:207], v[232:235], v[44:47], v[204:207]
    ds_read_b64_tr_b16 v[230:231], v249 offset:12288
    v_mfma_f32_16x16x32_bf16 v[192:195], v[236:239], v[48:51], v[192:195]
    buffer_store_dwordx4 v[240:243], v251, s[20:23], s34 offen sc1
    v_mfma_f32_16x16x32_bf16 v[196:199], v[236:239], v[52:55], v[196:199]
    ds_read_b64_tr_b16 v[232:233], v249 offset:1024
    v_mfma_f32_16x16x32_bf16 v[200:203], v[236:239], v[56:59], v[200:203]
    buffer_store_dwordx4 v[244:247], v251, s[20:23], s37 offen sc1
    v_mfma_f32_16x16x32_bf16 v[204:207], v[236:239], v[60:63], v[204:207]
    ds_read_b64_tr_b16 v[234:235], v249 offset:5120
    s_waitcnt lgkmcnt(4)
    v_mfma_f32_16x16x32_bf16 v[192:195], v[224:227], v[64:67], v[192:195]
    s_add_u32 s34, s34, 3145728
    s_add_u32 s37, s37, 3145728
    v_mfma_f32_16x16x32_bf16 v[196:199], v[224:227], v[68:71], v[196:199]
    ds_read_b64_tr_b16 v[236:237], v249 offset:9216
    v_mfma_f32_16x16x32_bf16 v[200:203], v[224:227], v[72:75], v[200:203]
    v_mfma_f32_16x16x32_bf16 v[204:207], v[224:227], v[76:79], v[204:207]
    ds_read_b64_tr_b16 v[238:239], v249 offset:13312
    s_waitcnt lgkmcnt(4)
    v_mfma_f32_16x16x32_bf16 v[192:195], v[228:231], v[80:83], v[192:195]
    v_mfma_f32_16x16x32_bf16 v[196:199], v[228:231], v[84:87], v[196:199]
    s_waitcnt vmcnt(3) lgkmcnt(0)
    s_barrier
    ds_read_b64_tr_b16 v[224:225], v249 offset:16384
    v_mfma_f32_16x16x32_bf16 v[200:203], v[228:231], v[88:91], v[200:203]
    v_mfma_f32_16x16x32_bf16 v[204:207], v[228:231], v[92:95], v[204:207]
    ds_read_b64_tr_b16 v[226:227], v249 offset:20480
    v_mfma_f32_16x16x32_bf16 v[192:195], v[232:235], v[96:99], v[192:195]
    v_mfma_f32_16x16x32_bf16 v[196:199], v[232:235], v[100:103], v[196:199]
    ds_read_b64_tr_b16 v[228:229], v249 offset:24576
    v_mfma_f32_16x16x32_bf16 v[200:203], v[232:235], v[104:107], v[200:203]
    v_mfma_f32_16x16x32_bf16 v[204:207], v[232:235], v[108:111], v[204:207]
    ds_read_b64_tr_b16 v[230:231], v249 offset:28672
    v_mfma_f32_16x16x32_bf16 v[192:195], v[236:239], v[112:115], v[192:195]
    v_mfma_f32_16x16x32_bf16 v[196:199], v[236:239], v[116:119], v[196:199]
    ds_read_b64_tr_b16 v[232:233], v249 offset:17408
    v_mfma_f32_16x16x32_bf16 v[200:203], v[236:239], v[120:123], v[200:203]
    v_mfma_f32_16x16x32_bf16 v[204:207], v[236:239], v[124:127], v[204:207]
    ds_read_b64_tr_b16 v[234:235], v249 offset:21504
    s_waitcnt lgkmcnt(4)
    v_mfma_f32_16x16x32_bf16 v[192:195], v[224:227], v[128:131], v[192:195]
    v_mfma_f32_16x16x32_bf16 v[196:199], v[224:227], v[132:135], v[196:199]
    ds_read_b64_tr_b16 v[236:237], v249 offset:25600
    v_mfma_f32_16x16x32_bf16 v[200:203], v[224:227], v[136:139], v[200:203]
    v_mfma_f32_16x16x32_bf16 v[204:207], v[224:227], v[140:143], v[204:207]
    ds_read_b64_tr_b16 v[238:239], v249 offset:29696
    s_waitcnt lgkmcnt(4)
    v_mfma_f32_16x16x32_bf16 v[192:195], v[228:231], v[144:147], v[192:195]
    v_mfma_f32_16x16x32_bf16 v[196:199], v[228:231], v[148:151], v[196:199]
    v_mfma_f32_16x16x32_bf16 v[200:203], v[228:231], v[152:155], v[200:203]
    v_mfma_f32_16x16x32_bf16 v[204:207], v[228:231], v[156:159], v[204:207]
    s_waitcnt lgkmcnt(2)
    v_mfma_f32_16x16x32_bf16 v[192:195], v[232:235], v[160:163], v[192:195]
    v_mfma_f32_16x16x32_bf16 v[196:199], v[232:235], v[164:167], v[196:199]
    v_mfma_f32_16x16x32_bf16 v[200:203], v[232:235], v[168:171], v[200:203]
    v_mfma_f32_16x16x32_bf16 v[204:207], v[232:235], v[172:175], v[204:207]
    s_waitcnt lgkmcnt(0)
    v_mfma_f32_16x16x32_bf16 v[192:195], v[236:239], v[176:179], v[192:195]
    v_mfma_f32_16x16x32_bf16 v[196:199], v[236:239], v[180:183], v[196:199]
    v_mfma_f32_16x16x32_bf16 v[200:203], v[236:239], v[184:187], v[200:203]
    v_mfma_f32_16x16x32_bf16 v[204:207], v[236:239], v[188:191], v[204:207]
    s_nop 7
    v_cvt_pk_bf16_f32 v240, v192, v193
    v_cvt_pk_bf16_f32 v241, v194, v195
    v_cvt_pk_bf16_f32 v242, v196, v197
    v_cvt_pk_bf16_f32 v243, v198, v199
    buffer_store_dwordx4 v[240:243], v251, s[20:23], s34 offen sc1
    v_cvt_pk_bf16_f32 v244, v200, v201
    v_cvt_pk_bf16_f32 v245, v202, v203
    v_cvt_pk_bf16_f32 v246, v204, v205
    v_cvt_pk_bf16_f32 v247, v206, v207
    buffer_store_dwordx4 v[244:247], v251, s[20:23], s37 offen sc1
    s_setprio 0
    s_lshl_b32 s40, s25, 7
    s_lshl_b32 s41, s26, 2
    s_add_u32 s40, s40, s41
    s_cmp_eq_u32 s24, 7
    s_cselect_b32 s40, s40, 2146435072
    v_mov_b32 v248, s40
    v_mov_b32 v253, 2146435072
    v_cmp_eq_u32 vcc, 0, v252
    v_mov_b32 v254, 9
    s_nop 0
    v_cndmask_b32 v253, v253, v248, vcc
    s_xor_b32 s25, s25, 8
    s_lshr_b32 s40, s26, 2
    s_cmp_ge_u32 s24, 4
    s_cselect_b32 s41, 4, 6
    s_cselect_b32 s42, 6, 9
    s_add_u32 s40, s40, s41
    s_cmp_ge_u32 s40, s42
    s_cbranch_scc1 L_fin_idle
    s_mov_b32 s4, s52
    s_and_b32 s5, s53, 0xffff
    s_mov_b32 s6, 2359296
    s_mov_b32 s7, 0x20000
    s_and_b32 s41, s26, 3
    s_lshl_b32 s42, s25, 2
    s_add_u32 s41, s41, s42
    s_lshl_b32 s43, s41, 2
    s_add_u32 s43, s43, s27
    s_lshl_b32 s43, s43, 10
    s_mul_i32 s44, s40, 3145728
    s_add_u32 s43, s43, s44
    v_and_b32 v0, 31, v252
    s_lshl_b32 s41, s41, 5
    v_add_u32 v0, s41, v0
    v_lshrrev_b32 v1, 5, v252
    s_lshl_b32 s42, s40, 2
    s_add_u32 s42, s42, s27
    s_lshl_b32 s42, s42, 1
    v_add_u32 v1, s42, v1
    v_lshl_add_u32 v2, v1, 11, v0
    v_lshlrev_b32 v2, 4, v2
    v_lshlrev_b32 v3, 2, v0
    v_mul_u32_u24 v4, 1152, v0
    v_lshl_add_u32 v4, v1, 4, v4
    v_lshrrev_b32 v5, 3, v252
    v_and_b32 v6, 7, v252
    v_lshlrev_b32 v5, 7, v5
    v_lshl_add_u32 v5, v6, 2, v5
    v_add_u32 v5, 2048, v5
    v_mov_b32 v6, 1
    s_lshl_b32 s44, s25, 7
    v_lshl_add_u32 v7, v252, 2, s44
    s_add_u32 s40, s40, 1
    v_mov_b32 v8, s40
    v_cmp_gt_u32 vcc, 12, v252
    s_mov_b32 s44, 29360128
    s_mov_b32 s45, 32505856
    v_cndmask_b32 v8, 0, v8, vcc
    v_mov_b32 v9, 2146435072
    v_cndmask_b32 v7, v9, v7, vcc
    s_sub_u32 s42, s42, 20
    v_add_u32 v5, s42, v252
    s_lshr_b32 s41, s41, 5
    v_mov_b32 v11, s41
    v_cmp_eq_u32 vcc, 14, v252
    v_subrev_u32 v16, 12, v252
    s_nop 0
    v_cndmask_b32 v5, v5, v11, vcc
    v_cmp_gt_u32 vcc, 3, v16
    v_lshrrev_b32 v11, 3, v5
    v_and_b32 v5, 7, v5
    v_lshlrev_b32 v11, 7, v11
    v_lshl_add_u32 v5, v5, 2, v11
    v_add_u32 v5, 2048, v5
    v_cndmask_b32 v7, v7, v5, vcc
    v_cndmask_b32 v8, v8, v6, vcc
    s_cmp_ge_u32 s24, 4
    s_cbranch_scc1 L_fin_b
    s_waitcnt vmcnt(0)
    s_barrier
    s_mov_b32 s101, 0
L_fp2:
    buffer_load_dword v9, v7, s[20:23], s36 offen sc1
    s_waitcnt vmcnt(0)
    v_cmp_lt_u32 vcc, v9, v8
    s_add_u32 s101, s101, 1
    s_cmp_lt_u32 s101, 50000
    s_cbranch_vccz L_fp2_ok
    s_sleep 2
    s_cbranch_scc1 L_fp2
L_fp2_ok:
    s_branch L_fp3_ok
L_fin_b:
    buffer_load_dword v9, v7, s[20:23], s36 offen sc1
    s_waitcnt vmcnt(1)
    s_barrier
    buffer_store_dword v254, v253, s[20:23], s36 offen sc1
    s_waitcnt vmcnt(1)
    v_cmp_lt_u32 vcc, v9, v8
    s_nop 1
    s_cbranch_vccz L_fp3_ok
    s_mov_b32 s101, 0
L_fp3:
    buffer_load_dword v9, v7, s[20:23], s36 offen sc1
    s_waitcnt vmcnt(0)
    v_cmp_lt_u32 vcc, v9, v8
    s_add_u32 s101, s101, 1
    s_cmp_lt_u32 s101, 50000
    s_cbranch_vccz L_fp3_ok
    s_sleep 8
    s_cbranch_scc1 L_fp3
L_fp3_ok:
    s_mov_b32 s46, s43
    buffer_load_dwordx4 v[16:19], v251, s[20:23], s46 offen sc1
    s_add_u32 s46, s46, 262144
    buffer_load_dwordx4 v[20:23], v251, s[20:23], s46 offen sc1
    s_add_u32 s46, s46, 262144
    buffer_load_dwordx4 v[24:27], v251, s[20:23], s46 offen sc1
    s_add_u32 s46, s46, 262144
    buffer_load_dwordx4 v[28:31], v251, s[20:23], s46 offen sc1
    s_add_u32 s46, s46, 262144
    buffer_load_dwordx4 v[32:35], v251, s[20:23], s46 offen sc1
    s_add_u32 s46, s46, 262144
    buffer_load_dwordx4 v[36:39], v251, s[20:23], s46 offen sc1
    s_add_u32 s46, s46, 262144
    buffer_load_dwordx4 v[40:43], v251, s[20:23], s46 offen sc1
    s_add_u32 s46, s46, 262144
    buffer_load_dwordx4 v[44:47], v251, s[20:23], s46 offen sc1
    s_add_u32 s46, s46, 262144
    buffer_load_dwordx4 v[48:51], v251, s[20:23], s46 offen sc1
    s_add_u32 s46, s46, 262144
    buffer_load_dwordx4 v[52:55], v251, s[20:23], s46 offen sc1
    s_add_u32 s46, s46, 262144
    buffer_load_dwordx4 v[56:59], v251, s[20:23], s46 offen sc1
    s_add_u32 s46, s46, 262144
    buffer_load_dwordx4 v[60:63], v251, s[20:23], s46 offen sc1
    buffer_load_dwordx4 v[12:15], v2, s[20:23], s44 offen sc1
    buffer_load_dword v10, v3, s[20:23], s45 offen sc1
L_fin_m:
    s_mov_b32 s46, 0x3f80
    s_mov_b32 s47, 0x3f800000
    s_waitcnt vmcnt(12)
    v_lshlrev_b32 v64, 16, v16
    v_and_b32 v65, 0xffff0000, v16
    v_lshlrev_b32 v66, 16, v17
    v_and_b32 v67, 0xffff0000, v17
    v_lshlrev_b32 v68, 16, v18
    v_and_b32 v69, 0xffff0000, v18
    v_lshlrev_b32 v70, 16, v19
    v_and_b32 v71, 0xffff0000, v19
    v_dot2_f32_bf16 v64, v20, s46, v64
    v_dot2_f32_bf16 v65, v20, s47, v65
    v_dot2_f32_bf16 v66, v21, s46, v66
    v_dot2_f32_bf16 v67, v21, s47, v67
    v_dot2_f32_bf16 v68, v22, s46, v68
    v_dot2_f32_bf16 v69, v22, s47, v69
    v_dot2_f32_bf16 v70, v23, s46, v70
    v_dot2_f32_bf16 v71, v23, s47, v71
    s_waitcnt vmcnt(10)
    v_dot2_f32_bf16 v64, v24, s46, v64
    v_dot2_f32_bf16 v65, v24, s47, v65
    v_dot2_f32_bf16 v66, v25, s46, v66
    v_dot2_f32_bf16 v67, v25, s47, v67
    v_dot2_f32_bf16 v68, v26, s46, v68
    v_dot2_f32_bf16 v69, v26, s47, v69
    v_dot2_f32_bf16 v70, v27, s46, v70
    v_dot2_f32_bf16 v71, v27, s47, v71
    v_dot2_f32_bf16 v64, v28, s46, v64
    v_dot2_f32_bf16 v65, v28, s47, v65
    v_dot2_f32_bf16 v66, v29, s46, v66
    v_dot2_f32_bf16 v67, v29, s47, v67
    v_dot2_f32_bf16 v68, v30, s46, v68
    v_dot2_f32_bf16 v69, v30, s47, v69
    v_dot2_f32_bf16 v70, v31, s46, v70
    v_dot2_f32_bf16 v71, v31, s47, v71
    s_waitcnt vmcnt(8)
    v_dot2_f32_bf16 v64, v32, s46, v64
    v_dot2_f32_bf16 v65, v32, s47, v65
    v_dot2_f32_bf16 v66, v33, s46, v66
    v_dot2_f32_bf16 v67, v33, s47, v67
    v_dot2_f32_bf16 v68, v34, s46, v68
    v_dot2_f32_bf16 v69, v34, s47, v69
    v_dot2_f32_bf16 v70, v35, s46, v70
    v_dot2_f32_bf16 v71, v35, s47, v71
    v_dot2_f32_bf16 v64, v36, s46, v64
    v_dot2_f32_bf16 v65, v36, s47, v65
    v_dot2_f32_bf16 v66, v37, s46, v66
    v_dot2_f32_bf16 v67, v37, s47, v67
    v_dot2_f32_bf16 v68, v38, s46, v68
    v_dot2_f32_bf16 v69, v38, s47, v69
    v_dot2_f32_bf16 v70, v39, s46, v70
    v_dot2_f32_bf16 v71, v39, s47, v71
    s_waitcnt vmcnt(6)
    v_dot2_f32_bf16 v64, v40, s46, v64
    v_dot2_f32_bf16 v65, v40, s47, v65
    v_dot2_f32_bf16 v66, v41, s46, v66
    v_dot2_f32_bf16 v67, v41, s47, v67
    v_dot2_f32_bf16 v68, v42, s46, v68
    v_dot2_f32_bf16 v69, v42, s47, v69
    v_dot2_f32_bf16 v70, v43, s46, v70
    v_dot2_f32_bf16 v71, v43, s47, v71
    v_dot2_f32_bf16 v64, v44, s46, v64
    v_dot2_f32_bf16 v65, v44, s47, v65
    v_dot2_f32_bf16 v66, v45, s46, v66
    v_dot2_f32_bf16 v67, v45, s47, v67
    v_dot2_f32_bf16 v68, v46, s46, v68
    v_dot2_f32_bf16 v69, v46, s47, v69
    v_dot2_f32_bf16 v70, v47, s46, v70
    v_dot2_f32_bf16 v71, v47, s47, v71
    s_waitcnt vmcnt(4)
    v_dot2_f32_bf16 v64, v48, s46, v64
    v_dot2_f32_bf16 v65, v48, s47, v65
    v_dot2_f32_bf16 v66, v49, s46, v66
    v_dot2_f32_bf16 v67, v49, s47, v67
    v_dot2_f32_bf16 v68, v50, s46, v68
    v_dot2_f32_bf16 v69, v50, s47, v69
    v_dot2_f32_bf16 v70, v51, s46, v70
    v_dot2_f32_bf16 v71, v51, s47, v71
    v_dot2_f32_bf16 v64, v52, s46, v64
    v_dot2_f32_bf16 v65, v52, s47, v65
    v_dot2_f32_bf16 v66, v53, s46, v66
    v_dot2_f32_bf16 v67, v53, s47, v67
    v_dot2_f32_bf16 v68, v54, s46, v68
    v_dot2_f32_bf16 v69, v54, s47, v69
    v_dot2_f32_bf16 v70, v55, s46, v70
    v_dot2_f32_bf16 v71, v55, s47, v71
    s_waitcnt vmcnt(2)
    v_dot2_f32_bf16 v64, v56, s46, v64
    v_dot2_f32_bf16 v65, v56, s47, v65
    v_dot2_f32_bf16 v66, v57, s46, v66
    v_dot2_f32_bf16 v67, v57, s47, v67
    v_dot2_f32_bf16 v68, v58, s46, v68
    v_dot2_f32_bf16 v69, v58, s47, v69
    v_dot2_f32_bf16 v70, v59, s46, v70
    v_dot2_f32_bf16 v71, v59, s47, v71
    v_dot2_f32_bf16 v64, v60, s46, v64
    v_dot2_f32_bf16 v65, v60, s47, v65
    v_dot2_f32_bf16 v66, v61, s46, v66
    v_dot2_f32_bf16 v67, v61, s47, v67
    v_dot2_f32_bf16 v68, v62, s46, v68
    v_dot2_f32_bf16 v69, v62, s47, v69
    v_dot2_f32_bf16 v70, v63, s46, v70
    v_dot2_f32_bf16 v71, v63, s47, v71
    s_waitcnt vmcnt(0)
    v_sub_f32 v11, 1.0, v10
    v_cvt_pk_bf16_f32 v11, v11, v11
    v_and_b32 v11, 0xffff0000, v11
    v_permlane16_swap_b32 v64, v68
    v_permlane16_swap_b32 v65, v69
    v_permlane16_swap_b32 v66, v70
    v_permlane16_swap_b32 v67, v71
    v_lshlrev_b32 v16, 16, v12
    v_and_b32 v17, 0xffff0000, v12
    v_lshlrev_b32 v18, 16, v13
    v_and_b32 v19, 0xffff0000, v13
    v_lshlrev_b32 v20, 16, v14
    v_and_b32 v21, 0xffff0000, v14
    v_lshlrev_b32 v22, 16, v15
    v_and_b32 v23, 0xffff0000, v15
    v_mul_f32 v16, v10, v16
    v_mul_f32 v17, v10, v17
    v_mul_f32 v18, v10, v18
    v_mul_f32 v19, v10, v19
    v_mul_f32 v20, v10, v20
    v_mul_f32 v21, v10, v21
    v_mul_f32 v22, v10, v22
    v_mul_f32 v23, v10, v23
    v_fmac_f32 v16, v11, v64
    v_fmac_f32 v17, v11, v65
    v_fmac_f32 v18, v11, v66
    v_fmac_f32 v19, v11, v67
    v_fmac_f32 v20, v11, v68
    v_fmac_f32 v21, v11, v69
    v_fmac_f32 v22, v11, v70
    v_fmac_f32 v23, v11, v71
    v_cvt_pk_bf16_f32 v24, v16, v17
    v_cvt_pk_bf16_f32 v25, v18, v19
    v_cvt_pk_bf16_f32 v26, v20, v21
    v_cvt_pk_bf16_f32 v27, v22, v23
    buffer_store_dwordx4 v[24:27], v4, s[4:7], 0 offen offset:0
    s_branch L_fin_done
L_fin_idle:
    s_waitcnt vmcnt(0)
    s_barrier
    buffer_store_dword v254, v253, s[20:23], s36 offen sc1
L_fin_done:
    s_endpgm
L_ssm:
    s_load_dwordx4 s[56:59], s[0:1], 8
    s_load_dwordx4 s[60:63], s[0:1], 24
    s_load_dwordx4 s[64:67], s[0:1], 40
    s_load_dwordx4 s[68:71], s[0:1], 56
    s_load_dwordx2 s[72:73], s[0:1], 104
    s_and_b32 s38, s2, 7
    s_lshr_b32 s39, s2, 3
    s_lshl_b32 s25, s38, 3
    s_add_u32 s25, s25, s39
    s_lshl_b32 s26, s25, 3
    s_add_u32 s26, s26, s24
    s_add_u32 s26, s26, 64
    s_mul_i32 s28, s24, 20480
    s_mov_b32 s27, 0
    s_mov_b32 s29, 29360128
    s_mov_b32 s30, 32505856
    s_mov_b32 s31, 32571392
    s_mov_b32 s32, 31981568
    s_lshl_b32 s78, s26, 8
    v_lshl_add_u32 v86, v252, 2, s78
    s_lshl_b32 s78, s26, 1
    v_mov_b32 v87, s78
    s_lshl_b32 s78, s25, 8
    v_lshl_add_u32 v88, v252, 2, s78
    s_lshl_b32 s78, s25, 1
    v_mov_b32 v89, s78
    v_mov_b32 v9, 2146435072
    v_lshl_add_u32 v82, v252, 2, s28
    v_mov_b32 v83, 0
    v_cmp_gt_u32 vcc, 16, v252
    s_and_saveexec_b64 s[80:81], vcc
    ds_write_b32 v82, v83 offset:448
    ds_write_b32 v83, v83 offset:40944
    s_mov_b64 exec, s[80:81]
    s_waitcnt lgkmcnt(0)
    s_mov_b32 s4, s40
    s_and_b32 s5, s41, 0xffff
    s_mov_b32 s6, 2359296
    s_mov_b32 s7, 0x20000
    s_mov_b32 s8, s50
    s_and_b32 s9, s51, 0xffff
    s_mov_b32 s10, 32575488
    s_mov_b32 s11, 0x20000
    s_mov_b32 s12, s52
    s_and_b32 s13, s53, 0xffff
    s_mov_b32 s14, 2359296
    s_mov_b32 s15, 0x20000
    s_mov_b32 s16, s44
    s_and_b32 s17, s45, 0xffff
    s_mov_b32 s18, 5308416
    s_mov_b32 s19, 0x20000
    s_mov_b32 s20, s48
    s_and_b32 s21, s49, 0xffff
    s_mov_b32 s22, 5308416
    s_mov_b32 s23, 0x20000
    v_mov_b32 v176, 2146435072
    v_mov_b32 v177, 2146435072
    s_mov_b32 s33, 0
    s_mov_b32 s34, 0
    global_load_dword v10, v86, s[56:57]
    global_load_dword v11, v86, s[58:59]
    global_load_dword v12, v86, s[60:61]
    global_load_dword v13, v86, s[62:63]
    global_load_dword v14, v86, s[64:65]
    global_load_dword v15, v86, s[66:67]
    global_load_ushort v16, v87, s[68:69]
    global_load_ushort v17, v87, s[70:71]
    global_load_dword v200, v88, s[56:57]
    global_load_dword v201, v88, s[58:59]
    global_load_dword v202, v88, s[60:61]
    global_load_dword v203, v88, s[62:63]
    global_load_dword v204, v88, s[64:65]
    global_load_dword v205, v88, s[66:67]
    global_load_ushort v206, v89, s[68:69]
    global_load_ushort v207, v89, s[70:71]
    s_cmp_ge_u32 s24, 4
    s_cbranch_scc1 L_young
    s_getpc_b64 s[74:75]
L_pc:
    s_sub_u32 s74, s74, L_pc - gated_mix__ssm_conv_s4__dense_activation_mish__prompt_kernel
    s_subb_u32 s75, s75, 0
    s_lshl_b32 s78, s39, 2
    s_add_u32 s78, s78, s24
    s_lshl_b32 s78, s78, 4
    v_and_b32 v5, 15, v252
    v_add_u32 v5, s78, v5
    v_lshlrev_b32 v5, 7, v5
    v_min_u32 v5, L_mainexit - gated_mix__ssm_conv_s4__dense_activation_mish__prompt_kernel, v5
    global_load_dword v251, v5, s[74:75]
    s_lshl_b32 s76, s39, 2
    s_add_u32 s76, s76, s24
    s_mul_i32 s76, s76, 55296
    s_lshr_b32 s79, s38, 1
    s_mul_i32 s79, s79, 2304
    s_add_u32 s76, s76, s79
    v_add_u32 v5, 0, v252
    v_mul_u32_u24 v91, 3641, v5
    v_lshrrev_b32 v91, 16, v91
    v_mul_u32_u24 v91, 6912, v91
    v_lshl_add_u32 v5, v5, 7, v91
    buffer_load_dword v251, v5, s[16:19], s76 offen
    v_add_u32 v5, 64, v252
    v_min_u32 v5, 107, v5
    v_mul_u32_u24 v91, 3641, v5
    v_lshrrev_b32 v91, 16, v91
    v_mul_u32_u24 v91, 6912, v91
    v_lshl_add_u32 v5, v5, 7, v91
    buffer_load_dword v251, v5, s[16:19], s76 offen
    s_waitcnt vmcnt(11)
    s_cmp_lt_u32 s24, 2
    s_cbranch_scc0 L_chan0
    s_waitcnt vmcnt(3)
    v_swap_b32 v10, v200
    v_swap_b32 v11, v201
    v_swap_b32 v12, v202
    v_swap_b32 v13, v203
    v_swap_b32 v14, v204
    v_swap_b32 v15, v205
    v_swap_b32 v16, v206
    v_swap_b32 v17, v207
    s_add_u32 s27, s24, 2
    s_branch L_chan0
L_young:
    s_sub_u32 s79, s24, 4
    s_or_b32 s74, s2, s79
    s_cmp_eq_u32 s74, 0
    s_cselect_b32 s78, 0, 2146435072
    v_lshl_add_u32 v90, v252, 4, s78
    v_mov_b32 v92, 0
    v_mov_b32 v93, 0
    v_mov_b32 v94, 0
    v_mov_b32 v95, 0
    buffer_store_dwordx4 v[92:95], v90, s[8:11], s31 offen offset:0 sc1
    buffer_store_dwordx4 v[92:95], v90, s[8:11], s31 offen offset:1024 sc1
    buffer_store_dwordx4 v[92:95], v90, s[8:11], s31 offen offset:2048 sc1
    s_lshl_b32 s78, s79, 9
    v_add_u32 v4, s78, v252
    v_mul_u32_u24 v5, 1152, v4
    s_lshl_b32 s33, s25, 4
    s_add_u32 s33, s33, 128
    buffer_load_dwordx4 v[112:115], v5, s[4:7], s33 offen
    s_add_u32 s33, s33, 73728
    buffer_load_dwordx4 v[116:119], v5, s[4:7], s33 offen
    s_add_u32 s33, s33, 73728
    buffer_load_dwordx4 v[120:123], v5, s[4:7], s33 offen
    s_add_u32 s33, s33, 73728
    buffer_load_dwordx4 v[124:127], v5, s[4:7], s33 offen
    s_add_u32 s33, s33, 73728
    buffer_load_dwordx4 v[128:131], v5, s[4:7], s33 offen
    s_add_u32 s33, s33, 73728
    buffer_load_dwordx4 v[132:135], v5, s[4:7], s33 offen
    s_add_u32 s33, s33, 73728
    buffer_load_dwordx4 v[136:139], v5, s[4:7], s33 offen
    s_add_u32 s33, s33, 73728
    buffer_load_dwordx4 v[140:143], v5, s[4:7], s33 offen
    v_lshrrev_b32 v80, 5, v4
    v_lshlrev_b32 v80, 6, v80
    v_and_b32 v81, 31, v4
    v_xor_b32 v81, 7, v81
    v_lshl_add_u32 v80, v81, 1, v80
    v_add_u32 v80, 512, v80
    v_add_u32 v81, 81920, v80
    v_xor_b32 v78, 32, v80
    v_xor_b32 v79, 32, v81
    s_waitcnt vmcnt(7)
    s_cmp_eq_u32 s74, 0
    s_cbranch_scc0 L_noclr
    v_mov_b32 v84, 1
    s_mov_b64 exec, 1
    global_store_dword v83, v84, s[54:55] sc1
    s_mov_b64 exec, s[80:81]
    s_waitcnt vmcnt(0)
L_noclr:
    ds_write_b16 v80, v112 offset:0
    ds_write_b16_d16_hi v80, v112 offset:20480
    ds_write_b16 v80, v113 offset:40960
    ds_write_b16_d16_hi v80, v113 offset:61440
    ds_write_b16 v81, v114 offset:0
    ds_write_b16_d16_hi v81, v114 offset:20480
    ds_write_b16 v81, v115 offset:40960
    ds_write_b16_d16_hi v81, v115 offset:61440
    s_waitcnt vmcnt(6) lgkmcnt(7)
    ds_write_b16 v80, v116 offset:128
    ds_write_b16_d16_hi v80, v116 offset:20608
    ds_write_b16 v80, v117 offset:41088
    ds_write_b16_d16_hi v80, v117 offset:61568
    ds_write_b16 v81, v118 offset:128
    ds_write_b16_d16_hi v81, v118 offset:20608
    ds_write_b16 v81, v119 offset:41088
    ds_write_b16_d16_hi v81, v119 offset:61568
    s_waitcnt vmcnt(5) lgkmcnt(7)
    ds_write_b16 v78, v120 offset:256
    ds_write_b16_d16_hi v78, v120 offset:20736
    ds_write_b16 v78, v121 offset:41216
    ds_write_b16_d16_hi v78, v121 offset:61696
    ds_write_b16 v79, v122 offset:256
    ds_write_b16_d16_hi v79, v122 offset:20736
    ds_write_b16 v79, v123 offset:41216
    ds_write_b16_d16_hi v79, v123 offset:61696
    s_waitcnt vmcnt(4) lgkmcnt(7)
    ds_write_b16 v78, v124 offset:384
    ds_write_b16_d16_hi v78, v124 offset:20864
    ds_write_b16 v78, v125 offset:41344
    ds_write_b16_d16_hi v78, v125 offset:61824
    ds_write_b16 v79, v126 offset:384
    ds_write_b16_d16_hi v79, v126 offset:20864
    ds_write_b16 v79, v127 offset:41344
    ds_write_b16_d16_hi v79, v127 offset:61824
    s_waitcnt vmcnt(3) lgkmcnt(7)
    ds_write_b16 v80, v128 offset:512
    ds_write_b16_d16_hi v80, v128 offset:20992
    ds_write_b16 v80, v129 offset:41472
    ds_write_b16_d16_hi v80, v129 offset:61952
    ds_write_b16 v81, v130 offset:512
    ds_write_b16_d16_hi v81, v130 offset:20992
    ds_write_b16 v81, v131 offset:41472
    ds_write_b16_d16_hi v81, v131 offset:61952
    s_waitcnt vmcnt(2) lgkmcnt(7)
    ds_write_b16 v80, v132 offset:640
    ds_write_b16_d16_hi v80, v132 offset:21120
    ds_write_b16 v80, v133 offset:41600
    ds_write_b16_d16_hi v80, v133 offset:62080
    ds_write_b16 v81, v134 offset:640
    ds_write_b16_d16_hi v81, v134 offset:21120
    ds_write_b16 v81, v135 offset:41600
    ds_write_b16_d16_hi v81, v135 offset:62080
    s_waitcnt vmcnt(1) lgkmcnt(7)
    ds_write_b16 v78, v136 offset:768
    ds_write_b16_d16_hi v78, v136 offset:21248
    ds_write_b16 v78, v137 offset:41728
    ds_write_b16_d16_hi v78, v137 offset:62208
    ds_write_b16 v79, v138 offset:768
    ds_write_b16_d16_hi v79, v138 offset:21248
    ds_write_b16 v79, v139 offset:41728
    ds_write_b16_d16_hi v79, v139 offset:62208
    s_waitcnt vmcnt(0) lgkmcnt(7)
    ds_write_b16 v78, v140 offset:896
    ds_write_b16_d16_hi v78, v140 offset:21376
    ds_write_b16 v78, v141 offset:41856
    ds_write_b16_d16_hi v78, v141 offset:62336
    ds_write_b16 v79, v142 offset:896
    ds_write_b16_d16_hi v79, v142 offset:21376
    ds_write_b16 v79, v143 offset:41856
    ds_write_b16_d16_hi v79, v143 offset:62336
    s_waitcnt lgkmcnt(0)
    s_barrier
    s_setprio 1
L_chan0:
L_chan:
    v_lshlrev_b32 v18, 16, v16
    v_lshlrev_b32 v19, 16, v17
    v_mul_f32 v18, 0x3fb8aa3b, v18
    v_exp_f32 v18, v18
    v_lshl_add_u32 v20, v252, 2, s28
    v_cvt_pk_bf16_f32 v18, v18, v18
    v_and_b32 v2, 31, v252
    v_lshrrev_b32 v3, 5, v252
    v_and_b32 v18, 0xffff0000, v18
    v_mul_u32_u24 v21, 272, v2
    v_lshl_add_u32 v21, v3, 4, v21
    v_add_u32 v21, s28, v21
    s_cmp_eq_u32 s27, 3
    s_cbranch_scc1 L_ks1
    v_lshlrev_b32 v32, 16, v10
    v_lshlrev_b32 v33, 16, v11
    v_lshlrev_b32 v34, 16, v12
    v_lshlrev_b32 v35, 16, v13
    v_lshlrev_b32 v36, 16, v14
    v_lshlrev_b32 v37, 16, v15
    v_mul_f32 v32, v18, v32
    v_mul_f32 v33, v18, v33
    v_mul_f32 v34, v18, v34
    v_mul_f32 v35, v18, v35
    v_mul_f32 v32, 0x3fb8aa3b, v32
    v_mul_f32 v33, 0x3e22f983, v33
    v_pk_mul_f32 v[26:27], v[36:37], v[34:35] op_sel:[1,1] op_sel_hi:[1,0]
    v_mul_f32 v60, 0x3f800000, v32
    v_mul_f32 v61, 0x3f800000, v33
    v_mul_f32 v63, 0x41000000, v32
    v_mul_f32 v64, 0x41000000, v33
    v_mul_f32 v66, 0x43800000, v32
    v_mul_f32 v67, 0x43800000, v33
    v_pk_fma_f32 v[44:45], v[36:37], v[34:35], v[26:27] op_sel_hi:[0,1,1] neg_lo:[0,0,1]
    v_fract_f32 v61, v61
    v_fract_f32 v64, v64
    v_fract_f32 v67, v67
    v_exp_f32 v60, v60
    v_exp_f32 v63, v63
    v_exp_f32 v66, v66
    v_sin_f32 v62, v61
    v_sin_f32 v65, v64
    v_sin_f32 v68, v67
    v_cos_f32 v61, v61
    v_cos_f32 v64, v64
    v_cos_f32 v67, v67
    v_mul_f32 v39, v60, v62
    v_mul_f32 v41, v63, v65
    v_mul_f32 v43, v66, v68
    v_mul_f32 v38, v60, v61
    v_mul_f32 v40, v63, v64
    v_mul_f32 v42, v66, v67
    v_pk_mul_f32 v[28:29], v[40:41], v[40:41] op_sel:[1,1] op_sel_hi:[1,0]
    v_pk_mul_f32 v[30:31], v[44:45], v[38:39] op_sel:[1,1] op_sel_hi:[1,0]
    v_mov_b32 v60, 1.0
    v_pk_fma_f32 v[64:65], v[40:41], v[40:41], v[28:29] op_sel_hi:[0,1,1] neg_lo:[0,0,1]
    v_mov_b32 v61, 0
    v_mov_b32 v62, v40
    v_pk_mul_f32 v[26:27], v[64:65], v[64:65] op_sel:[1,1] op_sel_hi:[1,0]
    v_pk_mul_f32 v[24:25], v[64:65], v[40:41] op_sel:[1,1] op_sel_hi:[1,0]
    v_mov_b32 v63, v41
    v_pk_fma_f32 v[46:47], v[44:45], v[38:39], v[30:31] op_sel_hi:[0,1,1] neg_lo:[0,0,1]
    v_pk_fma_f32 v[68:69], v[64:65], v[64:65], v[26:27] op_sel_hi:[0,1,1] neg_lo:[0,0,1]
    v_pk_mul_f32 v[30:31], v[44:45], v[42:43] op_sel:[1,1] op_sel_hi:[1,0]
    v_pk_fma_f32 v[66:67], v[64:65], v[40:41], v[24:25] op_sel_hi:[0,1,1] neg_lo:[0,0,1]
    v_pk_mul_f32 v[28:29], v[60:61], v[68:69] op_sel:[1,1] op_sel_hi:[1,0]
    v_pk_mul_f32 v[24:25], v[62:63], v[68:69] op_sel:[1,1] op_sel_hi:[1,0]
    v_pk_fma_f32 v[70:71], v[44:45], v[42:43], v[30:31] op_sel_hi:[0,1,1] neg_lo:[0,0,1]
    v_cvt_pk_bf16_f32 v80, v60, v61
    v_cvt_pk_bf16_f32 v81, v62, v63
    v_pk_mul_f32 v[26:27], v[64:65], v[68:69] op_sel:[1,1] op_sel_hi:[1,0]
    v_pk_fma_f32 v[60:61], v[60:61], v[68:69], v[28:29] op_sel_hi:[0,1,1] neg_lo:[0,0,1]
    v_pk_fma_f32 v[62:63], v[62:63], v[68:69], v[24:25] op_sel_hi:[0,1,1] neg_lo:[0,0,1]
    v_cvt_pk_bf16_f32 v82, v64, v65
    v_pk_mul_f32 v[28:29], v[46:47], v[38:39] op_sel:[1,1] op_sel_hi:[1,0]
    v_pk_mul_f32 v[24:25], v[70:71], v[42:43] op_sel:[1,1] op_sel_hi:[1,0]
    v_pk_fma_f32 v[64:65], v[64:65], v[68:69], v[26:27] op_sel_hi:[0,1,1] neg_lo:[0,0,1]
    v_cvt_pk_bf16_f32 v79, v44, -v45
    v_cvt_pk_bf16_f32 v78, v70, -v71
    v_pk_mul_f32 v[30:31], v[66:67], v[68:69] op_sel:[1,1] op_sel_hi:[1,0]
    v_pk_mul_f32 v[26:27], v[60:61], v[68:69] op_sel:[1,1] op_sel_hi:[1,0]
    v_pk_fma_f32 v[48:49], v[46:47], v[38:39], v[28:29] op_sel_hi:[0,1,1] neg_lo:[0,0,1]
    v_pk_fma_f32 v[70:71], v[70:71], v[42:43], v[24:25] op_sel_hi:[0,1,1] neg_lo:[0,0,1]
    v_cvt_pk_bf16_f32 v83, v66, v67
    v_cvt_pk_bf16_f32 v85, v60, v61
    v_pk_mul_f32 v[28:29], v[62:63], v[68:69] op_sel:[1,1] op_sel_hi:[1,0]
    ds_write_b32 v20, v79 offset:5200
    v_pk_fma_f32 v[66:67], v[66:67], v[68:69], v[30:31] op_sel_hi:[0,1,1] neg_lo:[0,0,1]
    v_pk_fma_f32 v[60:61], v[60:61], v[68:69], v[26:27] op_sel_hi:[0,1,1] neg_lo:[0,0,1]
    v_cvt_pk_bf16_f32 v79, v62, v63
    v_pk_mul_f32 v[30:31], v[48:49], v[38:39] op_sel:[1,1] op_sel_hi:[1,0]
    v_pk_mul_f32 v[26:27], v[70:71], v[42:43] op_sel:[1,1] op_sel_hi:[1,0]
    ds_write_b32 v20, v83 offset:12000
    v_pk_fma_f32 v[62:63], v[62:63], v[68:69], v[28:29] op_sel_hi:[0,1,1] neg_lo:[0,0,1]
    v_cvt_pk_bf16_f32 v84, v46, -v47
    v_cvt_pk_bf16_f32 v83, v70, -v71
    v_pk_mul_f32 v[24:25], v[64:65], v[68:69] op_sel:[1,1] op_sel_hi:[1,0]
    v_pk_mul_f32 v[28:29], v[66:67], v[68:69] op_sel:[1,1] op_sel_hi:[1,0]
    ds_write_b32 v20, v80 offset:11184
    ds_write_b32 v20, v82 offset:11728
    v_pk_fma_f32 v[50:51], v[48:49], v[38:39], v[30:31] op_sel_hi:[0,1,1] neg_lo:[0,0,1]
    v_pk_fma_f32 v[70:71], v[70:71], v[42:43], v[26:27] op_sel_hi:[0,1,1] neg_lo:[0,0,1]
    v_cvt_pk_bf16_f32 v80, v64, v65
    v_cvt_pk_bf16_f32 v82, v66, v67
    v_pk_mul_f32 v[30:31], v[60:61], v[68:69] op_sel:[1,1] op_sel_hi:[1,0]
    ds_write_b32 v20, v84 offset:5472
    v_pk_fma_f32 v[64:65], v[64:65], v[68:69], v[24:25] op_sel_hi:[0,1,1] neg_lo:[0,0,1]
    v_pk_fma_f32 v[66:67], v[66:67], v[68:69], v[28:29] op_sel_hi:[0,1,1] neg_lo:[0,0,1]
    v_cvt_pk_bf16_f32 v84, v60, v61
    v_pk_mul_f32 v[24:25], v[50:51], v[38:39] op_sel:[1,1] op_sel_hi:[1,0]
    v_pk_mul_f32 v[28:29], v[70:71], v[42:43] op_sel:[1,1] op_sel_hi:[1,0]
    ds_write_b32 v20, v81 offset:11456
    ds_write_b32 v20, v80 offset:12816
    v_pk_fma_f32 v[60:61], v[60:61], v[68:69], v[30:31] op_sel_hi:[0,1,1] neg_lo:[0,0,1]
    v_cvt_pk_bf16_f32 v81, v48, -v49
    v_cvt_pk_bf16_f32 v80, v70, -v71
    v_pk_mul_f32 v[26:27], v[62:63], v[68:69] op_sel:[1,1] op_sel_hi:[1,0]
    v_pk_mul_f32 v[30:31], v[64:65], v[68:69] op_sel:[1,1] op_sel_hi:[1,0]
    ds_write_b32 v20, v85 offset:12272
    ds_write_b32 v20, v79 offset:12544
    v_pk_fma_f32 v[52:53], v[50:51], v[38:39], v[24:25] op_sel_hi:[0,1,1] neg_lo:[0,0,1]
    v_pk_fma_f32 v[70:71], v[70:71], v[42:43], v[28:29] op_sel_hi:[0,1,1] neg_lo:[0,0,1]
    v_cvt_pk_bf16_f32 v85, v62, v63
    v_cvt_pk_bf16_f32 v79, v64, v65
    v_pk_mul_f32 v[24:25], v[66:67], v[68:69] op_sel:[1,1] op_sel_hi:[1,0]
    ds_write_b32 v20, v81 offset:5744
    v_pk_fma_f32 v[62:63], v[62:63], v[68:69], v[26:27] op_sel_hi:[0,1,1] neg_lo:[0,0,1]
    v_pk_fma_f32 v[64:65], v[64:65], v[68:69], v[30:31] op_sel_hi:[0,1,1] neg_lo:[0,0,1]
    v_cvt_pk_bf16_f32 v81, v66, v67
    v_pk_mul_f32 v[26:27], v[52:53], v[38:39] op_sel:[1,1] op_sel_hi:[1,0]
    v_pk_mul_f32 v[30:31], v[70:71], v[42:43] op_sel:[1,1] op_sel_hi:[1,0]
    ds_write_b32 v20, v78 offset:7376
    ds_write_b32 v20, v85 offset:13632
    v_pk_fma_f32 v[66:67], v[66:67], v[68:69], v[24:25] op_sel_hi:[0,1,1] neg_lo:[0,0,1]
    v_cvt_pk_bf16_f32 v78, v50, -v51
    v_cvt_pk_bf16_f32 v85, v70, -v71
    v_pk_mul_f32 v[28:29], v[60:61], v[68:69] op_sel:[1,1] op_sel_hi:[1,0]
    v_pk_mul_f32 v[24:25], v[62:63], v[68:69] op_sel:[1,1] op_sel_hi:[1,0]
    ds_write_b32 v20, v82 offset:13088
    ds_write_b32 v20, v84 offset:13360
    v_pk_fma_f32 v[54:55], v[52:53], v[38:39], v[26:27] op_sel_hi:[0,1,1] neg_lo:[0,0,1]
    v_pk_fma_f32 v[70:71], v[70:71], v[42:43], v[30:31] op_sel_hi:[0,1,1] neg_lo:[0,0,1]
    v_cvt_pk_bf16_f32 v82, v60, v61
    v_cvt_pk_bf16_f32 v84, v62, v63
    v_pk_mul_f32 v[26:27], v[64:65], v[68:69] op_sel:[1,1] op_sel_hi:[1,0]
    ds_write_b32 v20, v78 offset:6016
    v_pk_fma_f32 v[60:61], v[60:61], v[68:69], v[28:29] op_sel_hi:[0,1,1] neg_lo:[0,0,1]
    v_pk_fma_f32 v[62:63], v[62:63], v[68:69], v[24:25] op_sel_hi:[0,1,1] neg_lo:[0,0,1]
    v_cvt_pk_bf16_f32 v78, v64, v65
    v_pk_mul_f32 v[28:29], v[54:55], v[38:39] op_sel:[1,1] op_sel_hi:[1,0]
    v_pk_mul_f32 v[24:25], v[70:71], v[42:43] op_sel:[1,1] op_sel_hi:[1,0]
    ds_write_b32 v20, v83 offset:7920
    ds_write_b32 v20, v82 offset:14448
    v_pk_fma_f32 v[64:65], v[64:65], v[68:69], v[26:27] op_sel_hi:[0,1,1] neg_lo:[0,0,1]
    v_cvt_pk_bf16_f32 v83, v52, -v53
    v_cvt_pk_bf16_f32 v82, v70, -v71
    v_pk_mul_f32 v[30:31], v[66:67], v[68:69] op_sel:[1,1] op_sel_hi:[1,0]
    v_pk_mul_f32 v[26:27], v[60:61], v[68:69] op_sel:[1,1] op_sel_hi:[1,0]
    ds_write_b32 v20, v79 offset:13904
    ds_write_b32 v20, v81 offset:14176
    v_pk_fma_f32 v[56:57], v[54:55], v[38:39], v[28:29] op_sel_hi:[0,1,1] neg_lo:[0,0,1]
    v_pk_fma_f32 v[70:71], v[70:71], v[42:43], v[24:25] op_sel_hi:[0,1,1] neg_lo:[0,0,1]
    v_cvt_pk_bf16_f32 v79, v66, v67
    v_cvt_pk_bf16_f32 v81, v60, v61
    v_pk_mul_f32 v[28:29], v[62:63], v[68:69] op_sel:[1,1] op_sel_hi:[1,0]
    ds_write_b32 v20, v83 offset:6288
    v_pk_fma_f32 v[66:67], v[66:67], v[68:69], v[30:31] op_sel_hi:[0,1,1] neg_lo:[0,0,1]
    v_pk_fma_f32 v[60:61], v[60:61], v[68:69], v[26:27] op_sel_hi:[0,1,1] neg_lo:[0,0,1]
    v_cvt_pk_bf16_f32 v83, v62, v63
    v_pk_mul_f32 v[30:31], v[56:57], v[38:39] op_sel:[1,1] op_sel_hi:[1,0]
    v_pk_mul_f32 v[26:27], v[70:71], v[42:43] op_sel:[1,1] op_sel_hi:[1,0]
    ds_write_b32 v20, v80 offset:9008
    ds_write_b32 v20, v79 offset:15264
    v_pk_fma_f32 v[62:63], v[62:63], v[68:69], v[28:29] op_sel_hi:[0,1,1] neg_lo:[0,0,1]
    v_cvt_pk_bf16_f32 v80, v54, -v55
    v_cvt_pk_bf16_f32 v79, v70, -v71
    v_pk_mul_f32 v[28:29], v[66:67], v[68:69] op_sel:[1,1] op_sel_hi:[1,0]
    ds_write_b32 v20, v78 offset:14992
    v_pk_fma_f32 v[58:59], v[56:57], v[38:39], v[30:31] op_sel_hi:[0,1,1] neg_lo:[0,0,1]
    v_pk_fma_f32 v[70:71], v[70:71], v[42:43], v[26:27] op_sel_hi:[0,1,1] neg_lo:[0,0,1]
    v_cvt_pk_bf16_f32 v78, v66, v67
    v_pk_mul_f32 v[24:25], v[64:65], v[68:69] op_sel:[1,1] op_sel_hi:[1,0]
    v_pk_mul_f32 v[30:31], v[60:61], v[68:69] op_sel:[1,1] op_sel_hi:[1,0]
    v_pk_mul_f32 v[26:27], v[62:63], v[68:69] op_sel:[1,1] op_sel_hi:[1,0]
    ds_write_b32 v20, v84 offset:14720
    ds_write_b32 v20, v80 offset:6560
    ds_write_b32 v20, v81 offset:15536
    v_pk_fma_f32 v[66:67], v[66:67], v[68:69], v[28:29] op_sel_hi:[0,1,1] neg_lo:[0,0,1]
    v_cvt_pk_bf16_f32 v84, v64, v65
    v_cvt_pk_bf16_f32 v80, v60, v61
    v_cvt_pk_bf16_f32 v81, v62, v63
    v_pk_mul_f32 v[28:29], v[48:49], v[42:43] op_sel:[1,1] op_sel_hi:[1,0]
    v_pk_fma_f32 v[64:65], v[64:65], v[68:69], v[24:25] op_sel_hi:[0,1,1] neg_lo:[0,0,1]
    v_pk_fma_f32 v[60:61], v[60:61], v[68:69], v[30:31] op_sel_hi:[0,1,1] neg_lo:[0,0,1]
    v_pk_fma_f32 v[62:63], v[62:63], v[68:69], v[26:27] op_sel_hi:[0,1,1] neg_lo:[0,0,1]
    v_pk_mul_f32 v[24:25], v[70:71], v[42:43] op_sel:[1,1] op_sel_hi:[1,0]
    v_pk_mul_f32 v[26:27], v[52:53], v[42:43] op_sel:[1,1] op_sel_hi:[1,0]
    ds_write_b32 v20, v85 offset:9552
    ds_write_b32 v20, v84 offset:16080
    v_pk_fma_f32 v[72:73], v[48:49], v[42:43], v[28:29] op_sel_hi:[0,1,1] neg_lo:[0,0,1]
    v_cvt_pk_bf16_f32 v85, v56, -v57
    v_cvt_pk_bf16_f32 v84, v70, -v71
    v_pk_mul_f32 v[28:29], v[60:61], v[68:69] op_sel:[1,1] op_sel_hi:[1,0]
    ds_write_b32 v20, v78 offset:16352
    v_pk_fma_f32 v[70:71], v[70:71], v[42:43], v[24:25] op_sel_hi:[0,1,1] neg_lo:[0,0,1]
    v_pk_fma_f32 v[74:75], v[52:53], v[42:43], v[26:27] op_sel_hi:[0,1,1] neg_lo:[0,0,1]
    v_cvt_pk_bf16_f32 v78, v60, v61
    v_pk_mul_f32 v[30:31], v[64:65], v[68:69] op_sel:[1,1] op_sel_hi:[1,0]
    v_pk_mul_f32 v[24:25], v[66:67], v[68:69] op_sel:[1,1] op_sel_hi:[1,0]
    ds_write_b32 v20, v83 offset:15808
    ds_write_b32 v20, v85 offset:6832
    v_pk_fma_f32 v[60:61], v[60:61], v[68:69], v[28:29] op_sel_hi:[0,1,1] neg_lo:[0,0,1]
    v_cvt_pk_bf16_f32 v83, v64, v65
    v_cvt_pk_bf16_f32 v85, v66, v67
    v_pk_mul_f32 v[28:29], v[74:75], v[42:43] op_sel:[1,1] op_sel_hi:[1,0]
    ds_write_b32 v20, v84 offset:10912
    v_pk_fma_f32 v[64:65], v[64:65], v[68:69], v[30:31] op_sel_hi:[0,1,1] neg_lo:[0,0,1]
    v_pk_fma_f32 v[66:67], v[66:67], v[68:69], v[24:25] op_sel_hi:[0,1,1] neg_lo:[0,0,1]
    v_cvt_pk_bf16_f32 v84, v74, -v75
    v_pk_mul_f32 v[30:31], v[56:57], v[42:43] op_sel:[1,1] op_sel_hi:[1,0]
    v_pk_mul_f32 v[24:25], v[62:63], v[68:69] op_sel:[1,1] op_sel_hi:[1,0]
    ds_write_b32 v20, v82 offset:9824
    ds_write_b32 v20, v80 offset:16624
    ds_write_b32 v20, v81 offset:16896
    v_pk_fma_f32 v[74:75], v[74:75], v[42:43], v[28:29] op_sel_hi:[0,1,1] neg_lo:[0,0,1]
    v_cvt_pk_bf16_f32 v82, v58, -v59
    v_cvt_pk_bf16_f32 v80, v62, v63
    v_cvt_pk_bf16_f32 v81, v72, -v73
    v_pk_fma_f32 v[76:77], v[56:57], v[42:43], v[30:31] op_sel_hi:[0,1,1] neg_lo:[0,0,1]
    v_pk_fma_f32 v[62:63], v[62:63], v[68:69], v[24:25] op_sel_hi:[0,1,1] neg_lo:[0,0,1]
    v_pk_mul_f32 v[26:27], v[64:65], v[68:69] op_sel:[1,1] op_sel_hi:[1,0]
    v_pk_mul_f32 v[30:31], v[66:67], v[68:69] op_sel:[1,1] op_sel_hi:[1,0]
    v_pk_mul_f32 v[24:25], v[74:75], v[42:43] op_sel:[1,1] op_sel_hi:[1,0]
    ds_write_b32 v20, v79 offset:10640
    ds_write_b32 v20, v82 offset:7104
    ds_write_b32 v20, v83 offset:17168
    ds_write_b32 v20, v81 offset:7648
    v_cvt_pk_bf16_f32 v79, v70, -v71
    v_cvt_pk_bf16_f32 v82, v64, v65
    v_cvt_pk_bf16_f32 v83, v66, v67
    v_cvt_pk_bf16_f32 v81, v74, -v75
    v_pk_fma_f32 v[64:65], v[64:65], v[68:69], v[26:27] op_sel_hi:[0,1,1] neg_lo:[0,0,1]
    v_pk_fma_f32 v[66:67], v[66:67], v[68:69], v[30:31] op_sel_hi:[0,1,1] neg_lo:[0,0,1]
    v_pk_fma_f32 v[74:75], v[74:75], v[42:43], v[24:25] op_sel_hi:[0,1,1] neg_lo:[0,0,1]
    ds_write_b32 v20, v85 offset:17440
    ds_write_b32 v20, v78 offset:17712
    ds_write_b32 v20, v79 offset:10096
    ds_write_b32 v20, v80 offset:17984
    ds_write_b32 v20, v82 offset:18256
    ds_write_b32 v20, v83 offset:18528
    v_cvt_pk_bf16_f32 v85, v60, v61
    v_cvt_pk_bf16_f32 v78, v76, -v77
    v_cvt_pk_bf16_f32 v79, v62, v63
    v_cvt_pk_bf16_f32 v80, v64, v65
    v_cvt_pk_bf16_f32 v82, v66, v67
    v_cvt_pk_bf16_f32 v83, v74, -v75
    ds_write_b32 v20, v84 offset:8464
    ds_write_b32 v20, v85 offset:18800
    ds_write_b32 v20, v78 offset:8736
    ds_write_b32 v20, v79 offset:19072
    ds_write_b32 v20, v80 offset:19344
    ds_write_b32 v20, v81 offset:8192
    ds_write_b32 v20, v82 offset:19616
    ds_write_b32 v20, v83 offset:9280
    s_waitcnt lgkmcnt(0)
    ds_read_b128 v[112:115], v21 offset:5200
    ds_read_b128 v[116:119], v21 offset:11184
    ds_read_b128 v[120:123], v21 offset:5232
    ds_read_b128 v[124:127], v21 offset:11216
    ds_read_b128 v[128:131], v21 offset:5264
    ds_read_b128 v[132:135], v21 offset:11248
    ds_read_b128 v[136:139], v21 offset:5296
    ds_read_b128 v[140:143], v21 offset:11280
    ds_read_b128 v[144:147], v21 offset:5328
    ds_read_b128 v[148:151], v21 offset:11312
    ds_read_b128 v[152:155], v21 offset:5360
    ds_read_b128 v[156:159], v21 offset:11344
    ds_read_b128 v[160:163], v21 offset:5392
    ds_read_b128 v[164:167], v21 offset:11376
    s_waitcnt lgkmcnt(12)
    ds_read_b128 v[168:171], v21 offset:5424
    ds_read_b128 v[172:175], v21 offset:11408
L_ks1:
    v_and_b32 v32, 0xffff0000, v10
    v_and_b32 v33, 0xffff0000, v11
    v_and_b32 v34, 0xffff0000, v12
    v_and_b32 v35, 0xffff0000, v13
    v_and_b32 v36, 0xffff0000, v14
    v_and_b32 v37, 0xffff0000, v15
    v_mul_f32 v32, v18, v32
    v_mul_f32 v33, v18, v33
    v_mul_f32 v34, v18, v34
    v_mul_f32 v35, v18, v35
    v_mul_f32 v32, 0x3fb8aa3b, v32
    v_mul_f32 v33, 0x3e22f983, v33
    v_pk_mul_f32 v[26:27], v[36:37], v[34:35] op_sel:[1,1] op_sel_hi:[1,0]
    v_mul_f32 v60, 0x3f800000, v32
    v_mul_f32 v61, 0x3f800000, v33
    v_mul_f32 v63, 0x41000000, v32
    v_mul_f32 v64, 0x41000000, v33
    v_mul_f32 v66, 0x43800000, v32
    v_mul_f32 v67, 0x43800000, v33
    v_pk_fma_f32 v[44:45], v[36:37], v[34:35], v[26:27] op_sel_hi:[0,1,1] neg_lo:[0,0,1]
    v_fract_f32 v61, v61
    v_fract_f32 v64, v64
    v_fract_f32 v67, v67
    v_exp_f32 v60, v60
    v_exp_f32 v63, v63
    v_exp_f32 v66, v66
    v_sin_f32 v62, v61
    v_sin_f32 v65, v64
    v_sin_f32 v68, v67
    v_cos_f32 v61, v61
    v_cos_f32 v64, v64
    v_cos_f32 v67, v67
    v_mul_f32 v39, v60, v62
    v_mul_f32 v41, v63, v65
    v_mul_f32 v43, v66, v68
    v_mul_f32 v38, v60, v61
    v_mul_f32 v40, v63, v64
    v_mul_f32 v42, v66, v67
    s_cmp_eq_u32 s27, 3
    s_cbranch_scc0 L_ks2
    v_mov_b32 v96, 0
    v_mov_b32 v97, 0
    v_mov_b32 v98, 0
    v_mov_b32 v99, 0
    v_mov_b32 v100, 0
    v_mov_b32 v101, 0
    v_mov_b32 v102, 0
    v_mov_b32 v103, 0
    v_mov_b32 v104, 0
    v_mov_b32 v105, 0
    v_mov_b32 v106, 0
    v_mov_b32 v107, 0
    v_mov_b32 v108, 0
    v_mov_b32 v109, 0
    v_mov_b32 v110, 0
    v_mov_b32 v111, 0
    s_branch L_ks3
L_ks2:
    s_waitcnt lgkmcnt(12)
    v_mfma_f32_32x32x16_bf16 v[96:111], v[112:115], v[116:119], 0
    s_waitcnt lgkmcnt(12)
    v_mfma_f32_32x32x16_bf16 v[96:111], v[120:123], v[124:127], v[96:111]
    s_waitcnt lgkmcnt(10)
    v_mfma_f32_32x32x16_bf16 v[96:111], v[128:131], v[132:135], v[96:111]
    s_waitcnt lgkmcnt(8)
    v_mfma_f32_32x32x16_bf16 v[96:111], v[136:139], v[140:143], v[96:111]
    s_waitcnt lgkmcnt(6)
    v_mfma_f32_32x32x16_bf16 v[96:111], v[144:147], v[148:151], v[96:111]
    s_waitcnt lgkmcnt(4)
    v_mfma_f32_32x32x16_bf16 v[96:111], v[152:155], v[156:159], v[96:111]
    s_waitcnt lgkmcnt(2)
    v_mfma_f32_32x32x16_bf16 v[96:111], v[160:163], v[164:167], v[96:111]
    s_waitcnt lgkmcnt(0)
    v_mfma_f32_32x32x16_bf16 v[96:111], v[168:171], v[172:175], v[96:111]
    s_cmp_eq_u32 s27, 2
    s_cbranch_scc1 L_k9
L_ks3:
    v_pk_mul_f32 v[28:29], v[40:41], v[40:41] op_sel:[1,1] op_sel_hi:[1,0]
    v_pk_mul_f32 v[30:31], v[44:45], v[38:39] op_sel:[1,1] op_sel_hi:[1,0]
    v_mov_b32 v60, 1.0
    v_pk_fma_f32 v[64:65], v[40:41], v[40:41], v[28:29] op_sel_hi:[0,1,1] neg_lo:[0,0,1]
    v_mov_b32 v61, 0
    v_mov_b32 v62, v40
    v_pk_mul_f32 v[26:27], v[64:65], v[64:65] op_sel:[1,1] op_sel_hi:[1,0]
    v_pk_mul_f32 v[24:25], v[64:65], v[40:41] op_sel:[1,1] op_sel_hi:[1,0]
    v_mov_b32 v63, v41
    v_pk_fma_f32 v[46:47], v[44:45], v[38:39], v[30:31] op_sel_hi:[0,1,1] neg_lo:[0,0,1]
    v_pk_fma_f32 v[68:69], v[64:65], v[64:65], v[26:27] op_sel_hi:[0,1,1] neg_lo:[0,0,1]
    v_pk_mul_f32 v[30:31], v[44:45], v[42:43] op_sel:[1,1] op_sel_hi:[1,0]
    v_pk_fma_f32 v[66:67], v[64:65], v[40:41], v[24:25] op_sel_hi:[0,1,1] neg_lo:[0,0,1]
    v_pk_mul_f32 v[28:29], v[60:61], v[68:69] op_sel:[1,1] op_sel_hi:[1,0]
    v_pk_mul_f32 v[24:25], v[62:63], v[68:69] op_sel:[1,1] op_sel_hi:[1,0]
    v_pk_fma_f32 v[70:71], v[44:45], v[42:43], v[30:31] op_sel_hi:[0,1,1] neg_lo:[0,0,1]
    v_cvt_pk_bf16_f32 v85, v60, v61
    v_cvt_pk_bf16_f32 v78, v62, v63
    v_pk_mul_f32 v[26:27], v[64:65], v[68:69] op_sel:[1,1] op_sel_hi:[1,0]
    v_pk_fma_f32 v[60:61], v[60:61], v[68:69], v[28:29] op_sel_hi:[0,1,1] neg_lo:[0,0,1]
    v_pk_fma_f32 v[62:63], v[62:63], v[68:69], v[24:25] op_sel_hi:[0,1,1] neg_lo:[0,0,1]
    v_cvt_pk_bf16_f32 v79, v64, v65
    v_pk_mul_f32 v[28:29], v[46:47], v[38:39] op_sel:[1,1] op_sel_hi:[1,0]
    v_pk_mul_f32 v[24:25], v[70:71], v[42:43] op_sel:[1,1] op_sel_hi:[1,0]
    v_pk_fma_f32 v[64:65], v[64:65], v[68:69], v[26:27] op_sel_hi:[0,1,1] neg_lo:[0,0,1]
    v_cvt_pk_bf16_f32 v84, v44, -v45
    v_cvt_pk_bf16_f32 v83, v70, -v71
    v_pk_mul_f32 v[30:31], v[66:67], v[68:69] op_sel:[1,1] op_sel_hi:[1,0]
    v_pk_mul_f32 v[26:27], v[60:61], v[68:69] op_sel:[1,1] op_sel_hi:[1,0]
    v_pk_fma_f32 v[48:49], v[46:47], v[38:39], v[28:29] op_sel_hi:[0,1,1] neg_lo:[0,0,1]
    v_pk_fma_f32 v[70:71], v[70:71], v[42:43], v[24:25] op_sel_hi:[0,1,1] neg_lo:[0,0,1]
    v_cvt_pk_bf16_f32 v80, v66, v67
    v_cvt_pk_bf16_f32 v82, v60, v61
    v_pk_mul_f32 v[28:29], v[62:63], v[68:69] op_sel:[1,1] op_sel_hi:[1,0]
    ds_write_b32 v20, v84 offset:5200
    v_pk_fma_f32 v[66:67], v[66:67], v[68:69], v[30:31] op_sel_hi:[0,1,1] neg_lo:[0,0,1]
    v_pk_fma_f32 v[60:61], v[60:61], v[68:69], v[26:27] op_sel_hi:[0,1,1] neg_lo:[0,0,1]
    v_cvt_pk_bf16_f32 v84, v62, v63
    v_pk_mul_f32 v[30:31], v[48:49], v[38:39] op_sel:[1,1] op_sel_hi:[1,0]
    v_pk_mul_f32 v[26:27], v[70:71], v[42:43] op_sel:[1,1] op_sel_hi:[1,0]
    ds_write_b32 v20, v80 offset:12000
    v_pk_fma_f32 v[62:63], v[62:63], v[68:69], v[28:29] op_sel_hi:[0,1,1] neg_lo:[0,0,1]
    v_cvt_pk_bf16_f32 v81, v46, -v47
    v_cvt_pk_bf16_f32 v80, v70, -v71
    v_pk_mul_f32 v[24:25], v[64:65], v[68:69] op_sel:[1,1] op_sel_hi:[1,0]
    v_pk_mul_f32 v[28:29], v[66:67], v[68:69] op_sel:[1,1] op_sel_hi:[1,0]
    ds_write_b32 v20, v85 offset:11184
    ds_write_b32 v20, v79 offset:11728
    v_pk_fma_f32 v[50:51], v[48:49], v[38:39], v[30:31] op_sel_hi:[0,1,1] neg_lo:[0,0,1]
    v_pk_fma_f32 v[70:71], v[70:71], v[42:43], v[26:27] op_sel_hi:[0,1,1] neg_lo:[0,0,1]
    v_cvt_pk_bf16_f32 v85, v64, v65
    v_cvt_pk_bf16_f32 v79, v66, v67
    v_pk_mul_f32 v[30:31], v[60:61], v[68:69] op_sel:[1,1] op_sel_hi:[1,0]
    ds_write_b32 v20, v81 offset:5472
    v_pk_fma_f32 v[64:65], v[64:65], v[68:69], v[24:25] op_sel_hi:[0,1,1] neg_lo:[0,0,1]
    v_pk_fma_f32 v[66:67], v[66:67], v[68:69], v[28:29] op_sel_hi:[0,1,1] neg_lo:[0,0,1]
    v_cvt_pk_bf16_f32 v81, v60, v61
    v_pk_mul_f32 v[24:25], v[50:51], v[38:39] op_sel:[1,1] op_sel_hi:[1,0]
    v_pk_mul_f32 v[28:29], v[70:71], v[42:43] op_sel:[1,1] op_sel_hi:[1,0]
    ds_write_b32 v20, v78 offset:11456
    ds_write_b32 v20, v85 offset:12816
    v_pk_fma_f32 v[60:61], v[60:61], v[68:69], v[30:31] op_sel_hi:[0,1,1] neg_lo:[0,0,1]
    v_cvt_pk_bf16_f32 v78, v48, -v49
    v_cvt_pk_bf16_f32 v85, v70, -v71
    v_pk_mul_f32 v[26:27], v[62:63], v[68:69] op_sel:[1,1] op_sel_hi:[1,0]
    v_pk_mul_f32 v[30:31], v[64:65], v[68:69] op_sel:[1,1] op_sel_hi:[1,0]
    ds_write_b32 v20, v82 offset:12272
    ds_write_b32 v20, v84 offset:12544
    v_pk_fma_f32 v[52:53], v[50:51], v[38:39], v[24:25] op_sel_hi:[0,1,1] neg_lo:[0,0,1]
    v_pk_fma_f32 v[70:71], v[70:71], v[42:43], v[28:29] op_sel_hi:[0,1,1] neg_lo:[0,0,1]
    v_cvt_pk_bf16_f32 v82, v62, v63
    v_cvt_pk_bf16_f32 v84, v64, v65
    v_pk_mul_f32 v[24:25], v[66:67], v[68:69] op_sel:[1,1] op_sel_hi:[1,0]
    ds_write_b32 v20, v78 offset:5744
    v_pk_fma_f32 v[62:63], v[62:63], v[68:69], v[26:27] op_sel_hi:[0,1,1] neg_lo:[0,0,1]
    v_pk_fma_f32 v[64:65], v[64:65], v[68:69], v[30:31] op_sel_hi:[0,1,1] neg_lo:[0,0,1]
    v_cvt_pk_bf16_f32 v78, v66, v67
    v_pk_mul_f32 v[26:27], v[52:53], v[38:39] op_sel:[1,1] op_sel_hi:[1,0]
    v_pk_mul_f32 v[30:31], v[70:71], v[42:43] op_sel:[1,1] op_sel_hi:[1,0]
    ds_write_b32 v20, v83 offset:7376
    ds_write_b32 v20, v82 offset:13632
    v_pk_fma_f32 v[66:67], v[66:67], v[68:69], v[24:25] op_sel_hi:[0,1,1] neg_lo:[0,0,1]
    v_cvt_pk_bf16_f32 v83, v50, -v51
    v_cvt_pk_bf16_f32 v82, v70, -v71
    v_pk_mul_f32 v[28:29], v[60:61], v[68:69] op_sel:[1,1] op_sel_hi:[1,0]
    v_pk_mul_f32 v[24:25], v[62:63], v[68:69] op_sel:[1,1] op_sel_hi:[1,0]
    ds_write_b32 v20, v79 offset:13088
    ds_write_b32 v20, v81 offset:13360
    v_pk_fma_f32 v[54:55], v[52:53], v[38:39], v[26:27] op_sel_hi:[0,1,1] neg_lo:[0,0,1]
    v_pk_fma_f32 v[70:71], v[70:71], v[42:43], v[30:31] op_sel_hi:[0,1,1] neg_lo:[0,0,1]
    v_cvt_pk_bf16_f32 v79, v60, v61
    v_cvt_pk_bf16_f32 v81, v62, v63
    v_pk_mul_f32 v[26:27], v[64:65], v[68:69] op_sel:[1,1] op_sel_hi:[1,0]
    ds_write_b32 v20, v83 offset:6016
    v_pk_fma_f32 v[60:61], v[60:61], v[68:69], v[28:29] op_sel_hi:[0,1,1] neg_lo:[0,0,1]
    v_pk_fma_f32 v[62:63], v[62:63], v[68:69], v[24:25] op_sel_hi:[0,1,1] neg_lo:[0,0,1]
    v_cvt_pk_bf16_f32 v83, v64, v65
    v_pk_mul_f32 v[28:29], v[54:55], v[38:39] op_sel:[1,1] op_sel_hi:[1,0]
    v_pk_mul_f32 v[24:25], v[70:71], v[42:43] op_sel:[1,1] op_sel_hi:[1,0]
    ds_write_b32 v20, v80 offset:7920
    ds_write_b32 v20, v79 offset:14448
    v_pk_fma_f32 v[64:65], v[64:65], v[68:69], v[26:27] op_sel_hi:[0,1,1] neg_lo:[0,0,1]
    v_cvt_pk_bf16_f32 v80, v52, -v53
    v_cvt_pk_bf16_f32 v79, v70, -v71
    v_pk_mul_f32 v[30:31], v[66:67], v[68:69] op_sel:[1,1] op_sel_hi:[1,0]
    v_pk_mul_f32 v[26:27], v[60:61], v[68:69] op_sel:[1,1] op_sel_hi:[1,0]
    ds_write_b32 v20, v84 offset:13904
    ds_write_b32 v20, v78 offset:14176
    v_pk_fma_f32 v[56:57], v[54:55], v[38:39], v[28:29] op_sel_hi:[0,1,1] neg_lo:[0,0,1]
    v_pk_fma_f32 v[70:71], v[70:71], v[42:43], v[24:25] op_sel_hi:[0,1,1] neg_lo:[0,0,1]
    v_cvt_pk_bf16_f32 v84, v66, v67
    v_cvt_pk_bf16_f32 v78, v60, v61
    v_pk_mul_f32 v[28:29], v[62:63], v[68:69] op_sel:[1,1] op_sel_hi:[1,0]
    ds_write_b32 v20, v80 offset:6288
    v_pk_fma_f32 v[66:67], v[66:67], v[68:69], v[30:31] op_sel_hi:[0,1,1] neg_lo:[0,0,1]
    v_pk_fma_f32 v[60:61], v[60:61], v[68:69], v[26:27] op_sel_hi:[0,1,1] neg_lo:[0,0,1]
    v_cvt_pk_bf16_f32 v80, v62, v63
    v_pk_mul_f32 v[30:31], v[56:57], v[38:39] op_sel:[1,1] op_sel_hi:[1,0]
    v_pk_mul_f32 v[26:27], v[70:71], v[42:43] op_sel:[1,1] op_sel_hi:[1,0]
    ds_write_b32 v20, v85 offset:9008
    ds_write_b32 v20, v84 offset:15264
    v_pk_fma_f32 v[62:63], v[62:63], v[68:69], v[28:29] op_sel_hi:[0,1,1] neg_lo:[0,0,1]
    v_cvt_pk_bf16_f32 v85, v54, -v55
    v_cvt_pk_bf16_f32 v84, v70, -v71
    v_pk_mul_f32 v[28:29], v[66:67], v[68:69] op_sel:[1,1] op_sel_hi:[1,0]
    ds_write_b32 v20, v83 offset:14992
    v_pk_fma_f32 v[58:59], v[56:57], v[38:39], v[30:31] op_sel_hi:[0,1,1] neg_lo:[0,0,1]
    v_pk_fma_f32 v[70:71], v[70:71], v[42:43], v[26:27] op_sel_hi:[0,1,1] neg_lo:[0,0,1]
    v_cvt_pk_bf16_f32 v83, v66, v67
    v_pk_mul_f32 v[24:25], v[64:65], v[68:69] op_sel:[1,1] op_sel_hi:[1,0]
    v_pk_mul_f32 v[30:31], v[60:61], v[68:69] op_sel:[1,1] op_sel_hi:[1,0]
    v_pk_mul_f32 v[26:27], v[62:63], v[68:69] op_sel:[1,1] op_sel_hi:[1,0]
    ds_write_b32 v20, v81 offset:14720
    ds_write_b32 v20, v85 offset:6560
    ds_write_b32 v20, v78 offset:15536
    v_pk_fma_f32 v[66:67], v[66:67], v[68:69], v[28:29] op_sel_hi:[0,1,1] neg_lo:[0,0,1]
    v_cvt_pk_bf16_f32 v81, v64, v65
    v_cvt_pk_bf16_f32 v85, v60, v61
    v_cvt_pk_bf16_f32 v78, v62, v63
    v_pk_mul_f32 v[28:29], v[48:49], v[42:43] op_sel:[1,1] op_sel_hi:[1,0]
    v_pk_fma_f32 v[64:65], v[64:65], v[68:69], v[24:25] op_sel_hi:[0,1,1] neg_lo:[0,0,1]
    v_pk_fma_f32 v[60:61], v[60:61], v[68:69], v[30:31] op_sel_hi:[0,1,1] neg_lo:[0,0,1]
    v_pk_fma_f32 v[62:63], v[62:63], v[68:69], v[26:27] op_sel_hi:[0,1,1] neg_lo:[0,0,1]
    v_pk_mul_f32 v[24:25], v[70:71], v[42:43] op_sel:[1,1] op_sel_hi:[1,0]
    v_pk_mul_f32 v[26:27], v[52:53], v[42:43] op_sel:[1,1] op_sel_hi:[1,0]
    ds_write_b32 v20, v82 offset:9552
    ds_write_b32 v20, v81 offset:16080
    v_pk_fma_f32 v[72:73], v[48:49], v[42:43], v[28:29] op_sel_hi:[0,1,1] neg_lo:[0,0,1]
    v_cvt_pk_bf16_f32 v82, v56, -v57
    v_cvt_pk_bf16_f32 v81, v70, -v71
    v_pk_mul_f32 v[28:29], v[60:61], v[68:69] op_sel:[1,1] op_sel_hi:[1,0]
    ds_write_b32 v20, v83 offset:16352
    v_pk_fma_f32 v[70:71], v[70:71], v[42:43], v[24:25] op_sel_hi:[0,1,1] neg_lo:[0,0,1]
    v_pk_fma_f32 v[74:75], v[52:53], v[42:43], v[26:27] op_sel_hi:[0,1,1] neg_lo:[0,0,1]
    v_cvt_pk_bf16_f32 v83, v60, v61
    v_pk_mul_f32 v[30:31], v[64:65], v[68:69] op_sel:[1,1] op_sel_hi:[1,0]
    v_pk_mul_f32 v[24:25], v[66:67], v[68:69] op_sel:[1,1] op_sel_hi:[1,0]
    ds_write_b32 v20, v80 offset:15808
    ds_write_b32 v20, v82 offset:6832
    v_pk_fma_f32 v[60:61], v[60:61], v[68:69], v[28:29] op_sel_hi:[0,1,1] neg_lo:[0,0,1]
    v_cvt_pk_bf16_f32 v80, v64, v65
    v_cvt_pk_bf16_f32 v82, v66, v67
    v_pk_mul_f32 v[28:29], v[74:75], v[42:43] op_sel:[1,1] op_sel_hi:[1,0]
    ds_write_b32 v20, v81 offset:10912
    v_pk_fma_f32 v[64:65], v[64:65], v[68:69], v[30:31] op_sel_hi:[0,1,1] neg_lo:[0,0,1]
    v_pk_fma_f32 v[66:67], v[66:67], v[68:69], v[24:25] op_sel_hi:[0,1,1] neg_lo:[0,0,1]
    v_cvt_pk_bf16_f32 v81, v74, -v75
    v_pk_mul_f32 v[30:31], v[56:57], v[42:43] op_sel:[1,1] op_sel_hi:[1,0]
    v_pk_mul_f32 v[24:25], v[62:63], v[68:69] op_sel:[1,1] op_sel_hi:[1,0]
    ds_write_b32 v20, v79 offset:9824
    ds_write_b32 v20, v85 offset:16624
    ds_write_b32 v20, v78 offset:16896
    v_pk_fma_f32 v[74:75], v[74:75], v[42:43], v[28:29] op_sel_hi:[0,1,1] neg_lo:[0,0,1]
    v_cvt_pk_bf16_f32 v79, v58, -v59
    v_cvt_pk_bf16_f32 v85, v62, v63
    v_cvt_pk_bf16_f32 v78, v72, -v73
    v_pk_fma_f32 v[76:77], v[56:57], v[42:43], v[30:31] op_sel_hi:[0,1,1] neg_lo:[0,0,1]
    v_pk_fma_f32 v[62:63], v[62:63], v[68:69], v[24:25] op_sel_hi:[0,1,1] neg_lo:[0,0,1]
    v_pk_mul_f32 v[26:27], v[64:65], v[68:69] op_sel:[1,1] op_sel_hi:[1,0]
    v_pk_mul_f32 v[30:31], v[66:67], v[68:69] op_sel:[1,1] op_sel_hi:[1,0]
    v_pk_mul_f32 v[24:25], v[74:75], v[42:43] op_sel:[1,1] op_sel_hi:[1,0]
    ds_write_b32 v20, v84 offset:10640
    ds_write_b32 v20, v79 offset:7104
    ds_write_b32 v20, v80 offset:17168
    ds_write_b32 v20, v78 offset:7648
    v_cvt_pk_bf16_f32 v84, v70, -v71
    v_cvt_pk_bf16_f32 v79, v64, v65
    v_cvt_pk_bf16_f32 v80, v66, v67
    v_cvt_pk_bf16_f32 v78, v74, -v75
    v_pk_fma_f32 v[64:65], v[64:65], v[68:69], v[26:27] op_sel_hi:[0,1,1] neg_lo:[0,0,1]
    v_pk_fma_f32 v[66:67], v[66:67], v[68:69], v[30:31] op_sel_hi:[0,1,1] neg_lo:[0,0,1]
    v_pk_fma_f32 v[74:75], v[74:75], v[42:43], v[24:25] op_sel_hi:[0,1,1] neg_lo:[0,0,1]
    ds_write_b32 v20, v82 offset:17440
    ds_write_b32 v20, v83 offset:17712
    ds_write_b32 v20, v84 offset:10096
    ds_write_b32 v20, v85 offset:17984
    ds_write_b32 v20, v79 offset:18256
    ds_write_b32 v20, v80 offset:18528
    v_cvt_pk_bf16_f32 v82, v60, v61
    v_cvt_pk_bf16_f32 v83, v76, -v77
    v_cvt_pk_bf16_f32 v84, v62, v63
    v_cvt_pk_bf16_f32 v85, v64, v65
    v_cvt_pk_bf16_f32 v79, v66, v67
    v_cvt_pk_bf16_f32 v80, v74, -v75
    ds_write_b32 v20, v81 offset:8464
    ds_write_b32 v20, v82 offset:18800
    ds_write_b32 v20, v83 offset:8736
    ds_write_b32 v20, v84 offset:19072
    ds_write_b32 v20, v85 offset:19344
    ds_write_b32 v20, v78 offset:8192
    ds_write_b32 v20, v79 offset:19616
    ds_write_b32 v20, v80 offset:9280
    s_waitcnt lgkmcnt(0)
    ds_read_b128 v[112:115], v21 offset:5200
    ds_read_b128 v[116:119], v21 offset:11184
    ds_read_b128 v[120:123], v21 offset:5232
    ds_read_b128 v[124:127], v21 offset:11216
    ds_read_b128 v[128:131], v21 offset:5264
    ds_read_b128 v[132:135], v21 offset:11248
    ds_read_b128 v[136:139], v21 offset:5296
    ds_read_b128 v[140:143], v21 offset:11280
    ds_read_b128 v[144:147], v21 offset:5328
    ds_read_b128 v[148:151], v21 offset:11312
    ds_read_b128 v[152:155], v21 offset:5360
    ds_read_b128 v[156:159], v21 offset:11344
    ds_read_b128 v[160:163], v21 offset:5392
    ds_read_b128 v[164:167], v21 offset:11376
    s_waitcnt lgkmcnt(12)
    ds_read_b128 v[168:171], v21 offset:5424
    ds_read_b128 v[172:175], v21 offset:11408
    s_waitcnt lgkmcnt(12)
    v_mfma_f32_32x32x16_bf16 v[96:111], v[112:115], v[116:119], v[96:111]
    s_waitcnt lgkmcnt(12)
    v_mfma_f32_32x32x16_bf16 v[96:111], v[120:123], v[124:127], v[96:111]
    s_waitcnt lgkmcnt(10)
    v_mfma_f32_32x32x16_bf16 v[96:111], v[128:131], v[132:135], v[96:111]
    s_waitcnt lgkmcnt(8)
    v_mfma_f32_32x32x16_bf16 v[96:111], v[136:139], v[140:143], v[96:111]
    s_waitcnt lgkmcnt(6)
    v_mfma_f32_32x32x16_bf16 v[96:111], v[144:147], v[148:151], v[96:111]
    s_waitcnt lgkmcnt(4)
    v_mfma_f32_32x32x16_bf16 v[96:111], v[152:155], v[156:159], v[96:111]
    s_waitcnt lgkmcnt(2)
    v_mfma_f32_32x32x16_bf16 v[96:111], v[160:163], v[164:167], v[96:111]
    s_waitcnt lgkmcnt(0)
    v_mfma_f32_32x32x16_bf16 v[96:111], v[168:171], v[172:175], v[96:111]
    s_cmp_eq_u32 s27, 3
    s_cbranch_scc0 L_expand
L_k9:
    v_swap_b32 v10, v200
    v_swap_b32 v11, v201
    v_swap_b32 v12, v202
    v_swap_b32 v13, v203
    v_swap_b32 v14, v204
    v_swap_b32 v15, v205
    v_swap_b32 v16, v206
    v_swap_b32 v17, v207
    s_mov_b32 s27, 0
    s_nop 3
    v_mov_b32 v208, v96
    v_mov_b32 v209, v97
    v_mov_b32 v210, v98
    v_mov_b32 v211, v99
    v_mov_b32 v212, v100
    v_mov_b32 v213, v101
    v_mov_b32 v214, v102
    v_mov_b32 v215, v103
    v_mov_b32 v216, v104
    v_mov_b32 v217, v105
    v_mov_b32 v218, v106
    v_mov_b32 v219, v107
    v_mov_b32 v220, v108
    v_mov_b32 v221, v109
    v_mov_b32 v222, v110
    v_mov_b32 v223, v111
    s_branch L_chan
L_expand:
    v_lshlrev_b32 v23, 4, v2
    v_add_u32 v23, s28, v23
    v_lshl_add_u32 v32, v3, 10, v23
    v_lshl_add_u32 v33, v3, 9, v23
    v_add_u32 v33, 6284, v33
    v_lshl_add_u32 v34, v3, 3, v23
    v_lshl_add_u32 v35, v252, 2, s28
    v_mov_b32 v36, 0
    s_nop 7
    v_mov_b32_dpp v40, v104 quad_perm:[0,0,2,2] row_mask:0xf bank_mask:0xf
    v_mov_b32_dpp v41, v105 quad_perm:[0,0,2,2] row_mask:0xf bank_mask:0xf
    v_cvt_pk_bf16_f32 v44, v40, v104
    v_cvt_pk_bf16_f32 v45, v104, v104
    v_mov_b32 v46, v45
    v_mov_b32 v47, v45
    ds_write_b64 v32, v[44:45] offset:7304
    ds_write_b64 v32, v[46:47] offset:7312
    v_cvt_pk_bf16_f32 v48, v41, v105
    v_cvt_pk_bf16_f32 v49, v105, v105
    v_mov_b32 v50, v49
    v_mov_b32 v51, v49
    ds_write_b64 v32, v[48:49] offset:7816
    ds_write_b64 v32, v[50:51] offset:7824
    v_cvt_pk_bf16_f32 v52, v106, v106
    v_cvt_pk_bf16_f32 v54, v102, v102
    v_cvt_pk_bf16_f32 v55, v102, v103
    v_cvt_pk_bf16_f32 v56, v103, v103
    v_mov_b32 v53, v52
    v_cmp_gt_u32 vcc, 16, v252
    s_mov_b64 s[80:81], exec
    s_mov_b64 exec, 1
    ds_write_b64 v23, v[52:53] offset:9352
    s_mov_b64 exec, vcc
    ds_write_b32 v35, v36 offset:5200
    s_mov_b64 exec, s[80:81]
    ds_write2_b32 v33, v54, v54 offset0:0 offset1:1
    ds_write2_b32 v33, v55, v56 offset0:2 offset1:3
    v_cvt_pk_bf16_f32 v57, v100, v100
    v_cvt_pk_bf16_f32 v58, v101, v101
    v_cvt_pk_bf16_f32 v60, v96, v97
    v_cvt_pk_bf16_f32 v61, v98, v99
    ds_write_b16 v34, v57 offset:5774
    ds_write_b32 v34, v57 offset:5776
    ds_write_b16 v34, v58 offset:5780
    ds_write_b64 v34, v[60:61] offset:5264
    v_add_u32 v37, 5200, v35
    s_waitcnt lgkmcnt(0)
    ds_read2_b32 v[40:41], v37 offset0:0 offset1:1
    ds_read2_b32 v[42:43], v37 offset0:64 offset1:65
    ds_read2_b32 v[44:45], v37 offset0:128 offset1:129
    ds_read2_b32 v[46:47], v37 offset0:192 offset1:193
    s_waitcnt lgkmcnt(3)
    v_alignbit_b32 v48, v41, v40, 16
    ds_write_b32 v35, v48 offset:9364
    s_waitcnt lgkmcnt(3)
    v_alignbit_b32 v49, v43, v42, 16
    ds_write_b32 v35, v49 offset:9620
    s_waitcnt lgkmcnt(3)
    v_alignbit_b32 v50, v45, v44, 16
    ds_write_b32 v35, v50 offset:9876
    s_waitcnt lgkmcnt(3)
    v_alignbit_b32 v51, v47, v46, 16
    ds_write_b32 v35, v51 offset:10132
    v_add_u32 v37, 1024, v37
    ds_read2_b32 v[40:41], v37 offset0:0 offset1:1
    ds_read2_b32 v[42:43], v37 offset0:64 offset1:65
    ds_read2_b32 v[44:45], v37 offset0:128 offset1:129
    ds_read2_b32 v[46:47], v37 offset0:192 offset1:193
    s_waitcnt lgkmcnt(3)
    v_alignbit_b32 v48, v41, v40, 16
    ds_write_b32 v35, v48 offset:10388
    s_waitcnt lgkmcnt(3)
    v_alignbit_b32 v49, v43, v42, 16
    ds_write_b32 v35, v49 offset:10644
    s_waitcnt lgkmcnt(3)
    v_alignbit_b32 v50, v45, v44, 16
    ds_write_b32 v35, v50 offset:10900
    s_waitcnt lgkmcnt(3)
    v_alignbit_b32 v51, v47, v46, 16
    ds_write_b32 v35, v51 offset:11156
    v_add_u32 v37, 1024, v37
    ds_read2_b32 v[40:41], v37 offset0:0 offset1:1
    ds_read2_b32 v[42:43], v37 offset0:64 offset1:65
    ds_read2_b32 v[44:45], v37 offset0:128 offset1:129
    ds_read2_b32 v[46:47], v37 offset0:192 offset1:193
    s_waitcnt lgkmcnt(3)
    v_alignbit_b32 v48, v41, v40, 16
    ds_write_b32 v35, v48 offset:11412
    s_waitcnt lgkmcnt(3)
    v_alignbit_b32 v49, v43, v42, 16
    ds_write_b32 v35, v49 offset:11668
    s_waitcnt lgkmcnt(3)
    v_alignbit_b32 v50, v45, v44, 16
    ds_write_b32 v35, v50 offset:11924
    s_waitcnt lgkmcnt(3)
    v_alignbit_b32 v51, v47, v46, 16
    ds_write_b32 v35, v51 offset:12180
    v_add_u32 v37, 1024, v37
    ds_read2_b32 v[40:41], v37 offset0:0 offset1:1
    ds_read2_b32 v[42:43], v37 offset0:64 offset1:65
    ds_read2_b32 v[44:45], v37 offset0:128 offset1:129
    ds_read2_b32 v[46:47], v37 offset0:192 offset1:193
    s_waitcnt lgkmcnt(3)
    v_alignbit_b32 v48, v41, v40, 16
    ds_write_b32 v35, v48 offset:12436
    s_waitcnt lgkmcnt(3)
    v_alignbit_b32 v49, v43, v42, 16
    ds_write_b32 v35, v49 offset:12692
    s_waitcnt lgkmcnt(3)
    v_alignbit_b32 v50, v45, v44, 16
    ds_write_b32 v35, v50 offset:12948
    s_waitcnt lgkmcnt(3)
    v_alignbit_b32 v51, v47, v46, 16
    ds_write_b32 v35, v51 offset:13204
    v_add_u32 v37, 1024, v37
    s_mov_b64 exec, vcc
    ds_read2_b32 v[40:41], v37 offset0:0 offset1:1
    s_waitcnt lgkmcnt(0)
    v_alignbit_b32 v48, v41, v40, 16
    ds_write_b32 v35, v48 offset:13460
    v_add_u32 v37, 1024, v37
    s_mov_b64 exec, s[80:81]
    s_cmp_eq_u32 s27, 0
    s_cbranch_scc0 L_osig
    s_mov_b32 s35, s28
    s_mov_b32 s36, s28
    s_mov_b32 s37, 0
    s_mov_b32 s77, 99
    s_mov_b32 s78, 0
    s_cmp_ge_u32 s24, 4
    s_cbranch_scc1 L_convset
    v_lshl_add_u32 v32, v252, 4, s28
    s_cmp_lt_u32 s24, 2
    s_cbranch_scc0 L_nost
    ds_write_b128 v32, v[208:211] offset:13568
    ds_write_b128 v32, v[212:215] offset:14592
    ds_write_b128 v32, v[216:219] offset:15616
    ds_write_b128 v32, v[220:223] offset:16640
L_nost:
    s_lshl_b32 s76, s25, 5
    s_lshl_b32 s79, s24, 3
    s_add_u32 s76, s76, s79
    v_lshrrev_b32 v6, 4, v252
    v_add_u32 v6, s76, v6
    v_and_b32 v7, 15, v252
    v_lshlrev_b32 v7, 4, v7
    v_mul_u32_u24 v8, 1152, v6
    v_add_u32 v8, v8, v7
    v_cmp_gt_u32 vcc, 128, v7
    v_min_u32 v90, 112, v7
    s_mov_b32 s79, 4608
    v_cndmask_b32 v91, v9, v8, vcc
    global_load_dwordx4 v[180:183], v7, s[72:73] offset:0
    buffer_load_dwordx4 v[208:211], v8, s[4:7], 0 offen offset:0
    buffer_load_dwordx4 v[228:231], v8, s[4:7], s79 offen offset:0
    global_load_dwordx4 v[184:187], v7, s[72:73] offset:256
    buffer_load_dwordx4 v[212:215], v8, s[4:7], 0 offen offset:256
    buffer_load_dwordx4 v[232:235], v8, s[4:7], s79 offen offset:256
    global_load_dwordx4 v[188:191], v7, s[72:73] offset:512
    buffer_load_dwordx4 v[216:219], v8, s[4:7], 0 offen offset:512
    buffer_load_dwordx4 v[236:239], v8, s[4:7], s79 offen offset:512
    global_load_dwordx4 v[192:195], v7, s[72:73] offset:768
    buffer_load_dwordx4 v[220:223], v8, s[4:7], 0 offen offset:768
    buffer_load_dwordx4 v[240:243], v8, s[4:7], s79 offen offset:768
    global_load_dwordx4 v[196:199], v90, s[72:73] offset:1024
    buffer_load_dwordx4 v[224:227], v91, s[4:7], 0 offen offset:1024
    buffer_load_dwordx4 v[244:247], v91, s[4:7], s79 offen offset:1024
    s_lshl_b32 s79, s39, 2
    s_add_u32 s79, s79, s24
    s_lshr_b32 s76, s38, 1
    s_mul_i32 s33, s79, 110592
    s_mul_i32 s34, s76, 2304
    s_add_u32 s33, s33, s34
    s_add_u32 s33, s33, 1769472
    s_mul_i32 s34, s76, 1327104
    s_mul_i32 s79, s79, 41472
    s_add_u32 s34, s34, s79
    v_min_u32 v176, 53, v252
    v_lshlrev_b32 v177, 7, v176
    v_mul_u32_u24 v176, 3641, v176
    v_lshrrev_b32 v176, 16, v176
    v_mul_u32_u24 v176, 6912, v176
    v_add_u32 v176, v176, v177
    s_mov_b32 s77, 0
    s_waitcnt lgkmcnt(0)
    s_barrier
L_convset:
    s_setprio 0
    v_and_b32 v40, 15, v252
    v_lshrrev_b32 v41, 4, v252
    v_lshlrev_b32 v76, 4, v41
    v_lshlrev_b32 v77, 1, v40
    v_sub_u32 v77, v77, v76
    s_lshl_b32 s79, s37, 6
    s_add_u32 s79, s79, s35
    v_add_u32 v77, s79, v77
    v_and_b32 v78, 1, v40
    v_mov_b32 v79, 9412
    v_mov_b32 v43, 5250
    v_cmp_eq_u32 vcc, 1, v78
    s_add_u32 s79, s36, 448
    v_mov_b32 v38, s79
    v_lshlrev_b32 v42, 6, v40
    v_cndmask_b32 v79, v79, v43, vcc
    v_add_u32 v32, v77, v79
    v_add_u32 v33, 1024, v32
    v_add_u32 v34, 2048, v32
    v_add_u32 v35, 3072, v32
    s_lshl_b32 s79, s37, 6
    s_sub_u32 s79, s36, s79
    s_add_u32 s79, s79, 1536
    v_add_u32 v37, s79, v42
    v_mov_b32 v44, 0
    v_mov_b32 v45, 0
    v_mov_b32 v46, 0
    v_mov_b32 v47, 0
    v_mov_b32 v48, 0
    v_mov_b32 v49, 0
    v_mov_b32 v50, 0
    v_mov_b32 v51, 0
    v_mov_b32 v52, 0
    v_mov_b32 v53, 0
    v_mov_b32 v54, 0
    v_mov_b32 v55, 0
    v_mov_b32 v56, 0
    v_mov_b32 v57, 0
    v_mov_b32 v58, 0
    v_mov_b32 v59, 0
    v_mov_b32 v60, 0
    v_mov_b32 v61, 0
    v_mov_b32 v62, 0
    v_mov_b32 v63, 0
    v_mov_b32 v64, 0
    v_mov_b32 v65, 0
    v_mov_b32 v66, 0
    v_mov_b32 v67, 0
    v_mov_b32 v68, 0
    v_mov_b32 v69, 0
    v_mov_b32 v70, 0
    v_mov_b32 v71, 0
    v_mov_b32 v72, 0
    v_mov_b32 v73, 0
    v_mov_b32 v74, 0
    v_mov_b32 v75, 0
    s_waitcnt lgkmcnt(0)
    v_lshrrev_b32 v36, 3, v37
    v_bitop3_b32 v36, v36, 32, v76 bitop3:0x6a
    v_add_u32 v36, v36, v37
    v_subrev_u32 v37, 64, v37
    v_subrev_u32 v39, 1024, v36
    v_max_i32 v39, v39, v38
    ds_read_b128 v[112:115], v39
    ds_read_b128 v[116:119], v36 offset:0
    ds_read_b128 v[120:123], v36 offset:1024
    ds_read_b128 v[124:127], v36 offset:2048
    ds_read2_b32 v[80:81], v32 offset0:0 offset1:1
    ds_read2_b32 v[82:83], v32 offset0:2 offset1:3
    ds_read2_b32 v[84:85], v32 offset0:8 offset1:9
    ds_read2_b32 v[86:87], v32 offset0:10 offset1:11
    ds_read2_b32 v[88:89], v33 offset0:0 offset1:1
    ds_read2_b32 v[90:91], v33 offset0:2 offset1:3
    ds_read2_b32 v[92:93], v33 offset0:8 offset1:9
    ds_read2_b32 v[94:95], v33 offset0:10 offset1:11
    ds_read2_b32 v[96:97], v34 offset0:0 offset1:1
    ds_read2_b32 v[98:99], v34 offset0:2 offset1:3
    ds_read2_b32 v[100:101], v34 offset0:8 offset1:9
    s_waitcnt lgkmcnt(10)
    ds_read2_b32 v[102:103], v34 offset0:10 offset1:11
    ds_read2_b32 v[104:105], v35 offset0:0 offset1:1
    ds_read2_b32 v[106:107], v35 offset0:2 offset1:3
    ds_read2_b32 v[108:109], v35 offset0:8 offset1:9
    ds_read2_b32 v[110:111], v35 offset0:10 offset1:11
L_conv:
    s_cmp_ge_u32 s77, 5
    s_cbranch_scc1 L_pfn
    s_cmp_ge_u32 s77, 2
    s_cbranch_scc1 L_pfb
    buffer_load_dword v251, v176, s[16:19], s33 offen
    s_add_u32 s33, s33, 27648
    buffer_load_dword v251, v176, s[16:19], s33 offen
    s_add_u32 s33, s33, 27648
    s_branch L_pfc
L_pfb:
    buffer_load_dword v251, v177, s[20:23], s34 offen
    s_add_u32 s34, s34, 6912
    buffer_load_dword v251, v177, s[20:23], s34 offen
    s_add_u32 s34, s34, 6912
L_pfc:
    s_add_u32 s77, s77, 1
L_pfn:
    s_waitcnt lgkmcnt(14)
    v_mfma_f32_16x16x32_bf16 v[44:47], v[80:83], v[112:115], v[44:47]
    v_lshrrev_b32 v36, 3, v37
    v_bitop3_b32 v36, v36, 32, v76 bitop3:0x6a
    v_add_u32 v36, v36, v37
    v_mfma_f32_16x16x32_bf16 v[48:51], v[80:83], v[116:119], v[48:51]
    v_subrev_u32 v37, 64, v37
    v_subrev_u32 v39, 1024, v36
    v_max_i32 v39, v39, v38
    v_mfma_f32_16x16x32_bf16 v[52:55], v[80:83], v[120:123], v[52:55]
    ds_read_b128 v[160:163], v39
    s_waitcnt lgkmcnt(10)
    ds_read_b128 v[164:167], v36 offset:0
    v_mfma_f32_16x16x32_bf16 v[56:59], v[80:83], v[124:127], v[56:59]
    ds_read_b128 v[168:171], v36 offset:1024
    ds_read_b128 v[172:175], v36 offset:2048
    v_mfma_f32_16x16x32_bf16 v[60:63], v[84:87], v[112:115], v[60:63]
    ds_read2_b32 v[128:129], v32 offset0:16 offset1:17
    v_mfma_f32_16x16x32_bf16 v[64:67], v[84:87], v[116:119], v[64:67]
    ds_read2_b32 v[130:131], v32 offset0:18 offset1:19
    v_mfma_f32_16x16x32_bf16 v[68:71], v[84:87], v[120:123], v[68:71]
    s_waitcnt lgkmcnt(10)
    ds_read2_b32 v[132:133], v32 offset0:24 offset1:25
    v_mfma_f32_16x16x32_bf16 v[72:75], v[84:87], v[124:127], v[72:75]
    ds_read2_b32 v[134:135], v32 offset0:26 offset1:27
    v_mfma_f32_16x16x32_bf16 v[48:51], v[88:91], v[112:115], v[48:51]
    ds_read2_b32 v[136:137], v33 offset0:16 offset1:17
    v_mfma_f32_16x16x32_bf16 v[52:55], v[88:91], v[116:119], v[52:55]
    ds_read2_b32 v[138:139], v33 offset0:18 offset1:19
    v_mfma_f32_16x16x32_bf16 v[56:59], v[88:91], v[120:123], v[56:59]
    ds_read2_b32 v[140:141], v33 offset0:24 offset1:25
    v_mfma_f32_16x16x32_bf16 v[64:67], v[92:95], v[112:115], v[64:67]
    s_waitcnt lgkmcnt(10)
    ds_read2_b32 v[142:143], v33 offset0:26 offset1:27
    v_mfma_f32_16x16x32_bf16 v[68:71], v[92:95], v[116:119], v[68:71]
    ds_read2_b32 v[144:145], v34 offset0:16 offset1:17
    v_mfma_f32_16x16x32_bf16 v[72:75], v[92:95], v[120:123], v[72:75]
    ds_read2_b32 v[146:147], v34 offset0:18 offset1:19
    v_mfma_f32_16x16x32_bf16 v[52:55], v[96:99], v[112:115], v[52:55]
    ds_read2_b32 v[148:149], v34 offset0:24 offset1:25
    v_mfma_f32_16x16x32_bf16 v[56:59], v[96:99], v[116:119], v[56:59]
    ds_read2_b32 v[150:151], v34 offset0:26 offset1:27
    v_mfma_f32_16x16x32_bf16 v[68:71], v[100:103], v[112:115], v[68:71]
    s_waitcnt lgkmcnt(10)
    ds_read2_b32 v[152:153], v35 offset0:16 offset1:17
    v_mfma_f32_16x16x32_bf16 v[72:75], v[100:103], v[116:119], v[72:75]
    ds_read2_b32 v[154:155], v35 offset0:18 offset1:19
    v_mfma_f32_16x16x32_bf16 v[56:59], v[104:107], v[112:115], v[56:59]
    ds_read2_b32 v[156:157], v35 offset0:24 offset1:25
    v_mfma_f32_16x16x32_bf16 v[72:75], v[108:111], v[112:115], v[72:75]
    ds_read2_b32 v[158:159], v35 offset0:26 offset1:27
    v_mfma_f32_16x16x32_bf16 v[44:47], v[128:131], v[160:163], v[44:47]
    v_lshrrev_b32 v36, 3, v37
    v_bitop3_b32 v36, v36, 32, v76 bitop3:0x6a
    v_add_u32 v36, v36, v37
    v_mfma_f32_16x16x32_bf16 v[48:51], v[128:131], v[164:167], v[48:51]
    v_subrev_u32 v37, 64, v37
    v_subrev_u32 v39, 1024, v36
    v_max_i32 v39, v39, v38
    v_mfma_f32_16x16x32_bf16 v[52:55], v[128:131], v[168:171], v[52:55]
    ds_read_b128 v[112:115], v39
    s_waitcnt lgkmcnt(10)
    ds_read_b128 v[116:119], v36 offset:0
    v_mfma_f32_16x16x32_bf16 v[56:59], v[128:131], v[172:175], v[56:59]
    ds_read_b128 v[120:123], v36 offset:1024
    ds_read_b128 v[124:127], v36 offset:2048
    v_mfma_f32_16x16x32_bf16 v[60:63], v[132:135], v[160:163], v[60:63]
    ds_read2_b32 v[80:81], v32 offset0:32 offset1:33
    v_mfma_f32_16x16x32_bf16 v[64:67], v[132:135], v[164:167], v[64:67]
    ds_read2_b32 v[82:83], v32 offset0:34 offset1:35
    v_mfma_f32_16x16x32_bf16 v[68:71], v[132:135], v[168:171], v[68:71]
    s_waitcnt lgkmcnt(10)
    ds_read2_b32 v[84:85], v32 offset0:40 offset1:41
    v_mfma_f32_16x16x32_bf16 v[72:75], v[132:135], v[172:175], v[72:75]
    ds_read2_b32 v[86:87], v32 offset0:42 offset1:43
    v_mfma_f32_16x16x32_bf16 v[48:51], v[136:139], v[160:163], v[48:51]
    ds_read2_b32 v[88:89], v33 offset0:32 offset1:33
    v_mfma_f32_16x16x32_bf16 v[52:55], v[136:139], v[164:167], v[52:55]
    ds_read2_b32 v[90:91], v33 offset0:34 offset1:35
    v_mfma_f32_16x16x32_bf16 v[56:59], v[136:139], v[168:171], v[56:59]
    ds_read2_b32 v[92:93], v33 offset0:40 offset1:41
    v_mfma_f32_16x16x32_bf16 v[64:67], v[140:143], v[160:163], v[64:67]
    s_waitcnt lgkmcnt(10)
    ds_read2_b32 v[94:95], v33 offset0:42 offset1:43
    v_mfma_f32_16x16x32_bf16 v[68:71], v[140:143], v[164:167], v[68:71]
    ds_read2_b32 v[96:97], v34 offset0:32 offset1:33
    v_mfma_f32_16x16x32_bf16 v[72:75], v[140:143], v[168:171], v[72:75]
    ds_read2_b32 v[98:99], v34 offset0:34 offset1:35
    v_mfma_f32_16x16x32_bf16 v[52:55], v[144:147], v[160:163], v[52:55]
    ds_read2_b32 v[100:101], v34 offset0:40 offset1:41
    v_mfma_f32_16x16x32_bf16 v[56:59], v[144:147], v[164:167], v[56:59]
    ds_read2_b32 v[102:103], v34 offset0:42 offset1:43
    v_mfma_f32_16x16x32_bf16 v[68:71], v[148:151], v[160:163], v[68:71]
    s_waitcnt lgkmcnt(10)
    ds_read2_b32 v[104:105], v35 offset0:32 offset1:33
    v_mfma_f32_16x16x32_bf16 v[72:75], v[148:151], v[164:167], v[72:75]
    ds_read2_b32 v[106:107], v35 offset0:34 offset1:35
    v_mfma_f32_16x16x32_bf16 v[56:59], v[152:155], v[160:163], v[56:59]
    ds_read2_b32 v[108:109], v35 offset0:40 offset1:41
    v_mfma_f32_16x16x32_bf16 v[72:75], v[156:159], v[160:163], v[72:75]
    ds_read2_b32 v[110:111], v35 offset0:42 offset1:43
    v_add_u32 v32, 128, v32
    v_add_u32 v33, 128, v33
    v_add_u32 v34, 128, v34
    v_add_u32 v35, 128, v35
    s_add_u32 s78, s78, 1
    s_cmp_lt_u32 s78, 8
    s_cbranch_scc1 L_conv
    s_cmp_eq_u32 s27, 0
    s_cbranch_scc0 L_coopred
    v_lshrrev_b32 v32, 1, v41
    v_lshlrev_b32 v32, 4, v32
    v_and_b32 v33, 1, v41
    v_lshlrev_b32 v33, 3, v33
    v_sub_u32 v32, v32, v33
    v_add_u32 v32, v32, v42
    v_add_u32 v32, s28, v32
    v_bfe_u32 v34, v40, 2, 1
    v_lshlrev_b32 v34, 5, v34
    v_sub_u32 v35, v32, v34
    v_add_u32 v32, v32, v34
    s_and_b32 s78, s24, 3
    s_lshl_b32 s78, s78, 6
    s_add_u32 s78, s78, s28
    v_mul_u32_u24 v33, 72, v40
    v_lshl_add_u32 v33, v41, 3, v33
    v_add_u32 v33, s78, v33
    s_waitcnt lgkmcnt(0)
    ds_read_b64 v[80:81], v32 offset:520
    ds_read_b64 v[82:83], v32 offset:1544
    ds_read_b64 v[84:85], v32 offset:2568
    ds_read_b64 v[86:87], v32 offset:3592
    ds_read_b64 v[88:89], v35 offset:552
    ds_read_b64 v[90:91], v35 offset:1576
    ds_read_b64 v[92:93], v35 offset:2600
    ds_read_b64 v[94:95], v35 offset:3624
    s_waitcnt lgkmcnt(0)
    v_and_b32 v36, 0xffff0000, v81
    v_lshlrev_b32 v37, 16, v81
    v_and_b32 v38, 0xffff0000, v80
    v_lshlrev_b32 v39, 16, v80
    v_fmac_f32 v44, v19, v36
    v_fmac_f32 v45, v19, v37
    v_fmac_f32 v46, v19, v38
    v_fmac_f32 v47, v19, v39
    v_cvt_pk_bf16_f32 v80, v44, v45
    v_cvt_pk_bf16_f32 v81, v46, v47
    ds_write_b64 v33, v[80:81] offset:0
    v_and_b32 v36, 0xffff0000, v83
    v_lshlrev_b32 v37, 16, v83
    v_and_b32 v38, 0xffff0000, v82
    v_lshlrev_b32 v39, 16, v82
    v_fmac_f32 v48, v19, v36
    v_fmac_f32 v49, v19, v37
    v_fmac_f32 v50, v19, v38
    v_fmac_f32 v51, v19, v39
    v_cvt_pk_bf16_f32 v82, v48, v49
    v_cvt_pk_bf16_f32 v83, v50, v51
    ds_write_b64 v33, v[82:83] offset:1152
    v_and_b32 v36, 0xffff0000, v85
    v_lshlrev_b32 v37, 16, v85
    v_and_b32 v38, 0xffff0000, v84
    v_lshlrev_b32 v39, 16, v84
    v_fmac_f32 v52, v19, v36
    v_fmac_f32 v53, v19, v37
    v_fmac_f32 v54, v19, v38
    v_fmac_f32 v55, v19, v39
    v_cvt_pk_bf16_f32 v84, v52, v53
    v_cvt_pk_bf16_f32 v85, v54, v55
    ds_write_b64 v33, v[84:85] offset:2304
    v_and_b32 v36, 0xffff0000, v87
    v_lshlrev_b32 v37, 16, v87
    v_and_b32 v38, 0xffff0000, v86
    v_lshlrev_b32 v39, 16, v86
    v_fmac_f32 v56, v19, v36
    v_fmac_f32 v57, v19, v37
    v_fmac_f32 v58, v19, v38
    v_fmac_f32 v59, v19, v39
    v_cvt_pk_bf16_f32 v86, v56, v57
    v_cvt_pk_bf16_f32 v87, v58, v59
    ds_write_b64 v33, v[86:87] offset:3456
    v_and_b32 v36, 0xffff0000, v89
    v_lshlrev_b32 v37, 16, v89
    v_and_b32 v38, 0xffff0000, v88
    v_lshlrev_b32 v39, 16, v88
    v_fmac_f32 v60, v19, v36
    v_fmac_f32 v61, v19, v37
    v_fmac_f32 v62, v19, v38
    v_fmac_f32 v63, v19, v39
    v_cvt_pk_bf16_f32 v88, v60, v61
    v_cvt_pk_bf16_f32 v89, v62, v63
    ds_write_b64 v33, v[88:89] offset:32
    v_and_b32 v36, 0xffff0000, v91
    v_lshlrev_b32 v37, 16, v91
    v_and_b32 v38, 0xffff0000, v90
    v_lshlrev_b32 v39, 16, v90
    v_fmac_f32 v64, v19, v36
    v_fmac_f32 v65, v19, v37
    v_fmac_f32 v66, v19, v38
    v_fmac_f32 v67, v19, v39
    v_cvt_pk_bf16_f32 v90, v64, v65
    v_cvt_pk_bf16_f32 v91, v66, v67
    ds_write_b64 v33, v[90:91] offset:1184
    v_and_b32 v36, 0xffff0000, v93
    v_lshlrev_b32 v37, 16, v93
    v_and_b32 v38, 0xffff0000, v92
    v_lshlrev_b32 v39, 16, v92
    v_fmac_f32 v68, v19, v36
    v_fmac_f32 v69, v19, v37
    v_fmac_f32 v70, v19, v38
    v_fmac_f32 v71, v19, v39
    v_cvt_pk_bf16_f32 v92, v68, v69
    v_cvt_pk_bf16_f32 v93, v70, v71
    ds_write_b64 v33, v[92:93] offset:2336
    v_and_b32 v36, 0xffff0000, v95
    v_lshlrev_b32 v37, 16, v95
    v_and_b32 v38, 0xffff0000, v94
    v_lshlrev_b32 v39, 16, v94
    v_fmac_f32 v72, v19, v36
    v_fmac_f32 v73, v19, v37
    v_fmac_f32 v74, v19, v38
    v_fmac_f32 v75, v19, v39
    v_cvt_pk_bf16_f32 v94, v72, v73
    v_cvt_pk_bf16_f32 v95, v74, v75
    ds_write_b64 v33, v[94:95] offset:3488
    s_mov_b32 s27, 1
    s_cmp_ge_u32 s24, 4
    s_cbranch_scc1 L_coop
    s_waitcnt vmcnt(0)
    v_mov_b32 v84, 0
    v_mov_b32 v85, 0
    v_mov_b32 v86, 0
    v_mov_b32 v87, 0
    s_mov_b32 s79, 0x3f803f80
    v_lshlrev_b32 v96, 16, v180
    v_and_b32 v97, 0xffff0000, v180
    v_lshlrev_b32 v98, 16, v208
    v_and_b32 v99, 0xffff0000, v208
    v_lshlrev_b32 v102, 16, v228
    v_and_b32 v103, 0xffff0000, v228
    v_lshlrev_b32 v108, 16, v181
    v_and_b32 v109, 0xffff0000, v181
    v_lshlrev_b32 v110, 16, v209
    v_and_b32 v111, 0xffff0000, v209
    v_lshlrev_b32 v114, 16, v229
    v_and_b32 v115, 0xffff0000, v229
    v_mul_f32 v98, v98, v96
    v_mul_f32 v99, v99, v97
    v_mul_f32 v102, v102, v96
    v_mul_f32 v103, v103, v97
    v_mul_f32 v110, v110, v108
    v_mul_f32 v111, v111, v109
    v_mul_f32 v114, v114, v108
    v_mul_f32 v115, v115, v109
    v_lshlrev_b32 v120, 16, v182
    v_and_b32 v121, 0xffff0000, v182
    v_lshlrev_b32 v122, 16, v210
    v_and_b32 v123, 0xffff0000, v210
    v_lshlrev_b32 v126, 16, v230
    v_and_b32 v127, 0xffff0000, v230
    v_lshlrev_b32 v132, 16, v183
    v_and_b32 v133, 0xffff0000, v183
    v_lshlrev_b32 v134, 16, v211
    v_and_b32 v135, 0xffff0000, v211
    v_lshlrev_b32 v138, 16, v231
    v_and_b32 v139, 0xffff0000, v231
    v_cvt_pk_bf16_f32 v100, v98, v99
    v_cvt_pk_bf16_f32 v104, v102, v103
    v_cvt_pk_bf16_f32 v112, v110, v111
    v_cvt_pk_bf16_f32 v116, v114, v115
    v_mul_f32 v122, v122, v120
    v_mul_f32 v123, v123, v121
    v_mul_f32 v126, v126, v120
    v_mul_f32 v127, v127, v121
    v_mul_f32 v134, v134, v132
    v_mul_f32 v135, v135, v133
    v_mul_f32 v138, v138, v132
    v_mul_f32 v139, v139, v133
    v_lshlrev_b32 v96, 16, v184
    v_and_b32 v97, 0xffff0000, v184
    v_lshlrev_b32 v98, 16, v212
    v_and_b32 v99, 0xffff0000, v212
    v_lshlrev_b32 v102, 16, v232
    v_and_b32 v103, 0xffff0000, v232
    v_lshlrev_b32 v108, 16, v185
    v_and_b32 v109, 0xffff0000, v185
    v_lshlrev_b32 v110, 16, v213
    v_and_b32 v111, 0xffff0000, v213
    v_lshlrev_b32 v114, 16, v233
    v_and_b32 v115, 0xffff0000, v233
    v_cvt_pk_bf16_f32 v124, v122, v123
    v_cvt_pk_bf16_f32 v128, v126, v127
    v_cvt_pk_bf16_f32 v136, v134, v135
    v_cvt_pk_bf16_f32 v140, v138, v139
    v_mul_f32 v98, v98, v96
    v_mul_f32 v99, v99, v97
    v_mul_f32 v102, v102, v96
    v_mul_f32 v103, v103, v97
    v_mul_f32 v110, v110, v108
    v_mul_f32 v111, v111, v109
    v_mul_f32 v114, v114, v108
    v_mul_f32 v115, v115, v109
    v_lshlrev_b32 v120, 16, v186
    v_and_b32 v121, 0xffff0000, v186
    v_lshlrev_b32 v122, 16, v214
    v_and_b32 v123, 0xffff0000, v214
    v_lshlrev_b32 v126, 16, v234
    v_and_b32 v127, 0xffff0000, v234
    v_lshlrev_b32 v132, 16, v187
    v_and_b32 v133, 0xffff0000, v187
    v_lshlrev_b32 v134, 16, v215
    v_and_b32 v135, 0xffff0000, v215
    v_lshlrev_b32 v138, 16, v235
    v_and_b32 v139, 0xffff0000, v235
    v_dot2_f32_bf16 v84, v100, s79, v84
    v_dot2_f32_bf16 v86, v104, s79, v86
    v_dot2_f32_bf16 v85, v112, s79, v85
    v_dot2_f32_bf16 v87, v116, s79, v87
    v_cvt_pk_bf16_f32 v100, v98, v99
    v_cvt_pk_bf16_f32 v104, v102, v103
    v_cvt_pk_bf16_f32 v112, v110, v111
    v_cvt_pk_bf16_f32 v116, v114, v115
    v_mul_f32 v122, v122, v120
    v_mul_f32 v123, v123, v121
    v_mul_f32 v126, v126, v120
    v_mul_f32 v127, v127, v121
    v_mul_f32 v134, v134, v132
    v_mul_f32 v135, v135, v133
    v_mul_f32 v138, v138, v132
    v_mul_f32 v139, v139, v133
    v_dot2_f32_bf16 v84, v124, s79, v84
    v_dot2_f32_bf16 v86, v128, s79, v86
    v_dot2_f32_bf16 v85, v136, s79, v85
    v_dot2_f32_bf16 v87, v140, s79, v87
    v_lshlrev_b32 v96, 16, v188
    v_and_b32 v97, 0xffff0000, v188
    v_lshlrev_b32 v98, 16, v216
    v_and_b32 v99, 0xffff0000, v216
    v_lshlrev_b32 v102, 16, v236
    v_and_b32 v103, 0xffff0000, v236
    v_lshlrev_b32 v108, 16, v189
    v_and_b32 v109, 0xffff0000, v189
    v_lshlrev_b32 v110, 16, v217
    v_and_b32 v111, 0xffff0000, v217
    v_lshlrev_b32 v114, 16, v237
    v_and_b32 v115, 0xffff0000, v237
    v_cvt_pk_bf16_f32 v124, v122, v123
    v_cvt_pk_bf16_f32 v128, v126, v127
    v_cvt_pk_bf16_f32 v136, v134, v135
    v_cvt_pk_bf16_f32 v140, v138, v139
    v_mul_f32 v98, v98, v96
    v_mul_f32 v99, v99, v97
    v_mul_f32 v102, v102, v96
    v_mul_f32 v103, v103, v97
    v_mul_f32 v110, v110, v108
    v_mul_f32 v111, v111, v109
    v_mul_f32 v114, v114, v108
    v_mul_f32 v115, v115, v109
    v_lshlrev_b32 v120, 16, v190
    v_and_b32 v121, 0xffff0000, v190
    v_lshlrev_b32 v122, 16, v218
    v_and_b32 v123, 0xffff0000, v218
    v_lshlrev_b32 v126, 16, v238
    v_and_b32 v127, 0xffff0000, v238
    v_lshlrev_b32 v132, 16, v191
    v_and_b32 v133, 0xffff0000, v191
    v_lshlrev_b32 v134, 16, v219
    v_and_b32 v135, 0xffff0000, v219
    v_lshlrev_b32 v138, 16, v239
    v_and_b32 v139, 0xffff0000, v239
    v_dot2_f32_bf16 v84, v100, s79, v84
    v_dot2_f32_bf16 v86, v104, s79, v86
    v_dot2_f32_bf16 v85, v112, s79, v85
    v_dot2_f32_bf16 v87, v116, s79, v87
    v_cvt_pk_bf16_f32 v100, v98, v99
    v_cvt_pk_bf16_f32 v104, v102, v103
    v_cvt_pk_bf16_f32 v112, v110, v111
    v_cvt_pk_bf16_f32 v116, v114, v115
    v_mul_f32 v122, v122, v120
    v_mul_f32 v123, v123, v121
    v_mul_f32 v126, v126, v120
    v_mul_f32 v127, v127, v121
    v_mul_f32 v134, v134, v132
    v_mul_f32 v135, v135, v133
    v_mul_f32 v138, v138, v132
    v_mul_f32 v139, v139, v133
    v_dot2_f32_bf16 v84, v124, s79, v84
    v_dot2_f32_bf16 v86, v128, s79, v86
    v_dot2_f32_bf16 v85, v136, s79, v85
    v_dot2_f32_bf16 v87, v140, s79, v87
    v_lshlrev_b32 v96, 16, v192
    v_and_b32 v97, 0xffff0000, v192
    v_lshlrev_b32 v98, 16, v220
    v_and_b32 v99, 0xffff0000, v220
    v_lshlrev_b32 v102, 16, v240
    v_and_b32 v103, 0xffff0000, v240
    v_lshlrev_b32 v108, 16, v193
    v_and_b32 v109, 0xffff0000, v193
    v_lshlrev_b32 v110, 16, v221
    v_and_b32 v111, 0xffff0000, v221
    v_lshlrev_b32 v114, 16, v241
    v_and_b32 v115, 0xffff0000, v241
    v_cvt_pk_bf16_f32 v124, v122, v123
    v_cvt_pk_bf16_f32 v128, v126, v127
    v_cvt_pk_bf16_f32 v136, v134, v135
    v_cvt_pk_bf16_f32 v140, v138, v139
    v_mul_f32 v98, v98, v96
    v_mul_f32 v99, v99, v97
    v_mul_f32 v102, v102, v96
    v_mul_f32 v103, v103, v97
    v_mul_f32 v110, v110, v108
    v_mul_f32 v111, v111, v109
    v_mul_f32 v114, v114, v108
    v_mul_f32 v115, v115, v109
    v_lshlrev_b32 v120, 16, v194
    v_and_b32 v121, 0xffff0000, v194
    v_lshlrev_b32 v122, 16, v222
    v_and_b32 v123, 0xffff0000, v222
    v_lshlrev_b32 v126, 16, v242
    v_and_b32 v127, 0xffff0000, v242
    v_lshlrev_b32 v132, 16, v195
    v_and_b32 v133, 0xffff0000, v195
    v_lshlrev_b32 v134, 16, v223
    v_and_b32 v135, 0xffff0000, v223
    v_lshlrev_b32 v138, 16, v243
    v_and_b32 v139, 0xffff0000, v243
    v_dot2_f32_bf16 v84, v100, s79, v84
    v_dot2_f32_bf16 v86, v104, s79, v86
    v_dot2_f32_bf16 v85, v112, s79, v85
    v_dot2_f32_bf16 v87, v116, s79, v87
    v_cvt_pk_bf16_f32 v100, v98, v99
    v_cvt_pk_bf16_f32 v104, v102, v103
    v_cvt_pk_bf16_f32 v112, v110, v111
    v_cvt_pk_bf16_f32 v116, v114, v115
    v_mul_f32 v122, v122, v120
    v_mul_f32 v123, v123, v121
    v_mul_f32 v126, v126, v120
    v_mul_f32 v127, v127, v121
    v_mul_f32 v134, v134, v132
    v_mul_f32 v135, v135, v133
    v_mul_f32 v138, v138, v132
    v_mul_f32 v139, v139, v133
    v_dot2_f32_bf16 v84, v124, s79, v84
    v_dot2_f32_bf16 v86, v128, s79, v86
    v_dot2_f32_bf16 v85, v136, s79, v85
    v_dot2_f32_bf16 v87, v140, s79, v87
    v_lshlrev_b32 v96, 16, v196
    v_and_b32 v97, 0xffff0000, v196
    v_lshlrev_b32 v98, 16, v224
    v_and_b32 v99, 0xffff0000, v224
    v_lshlrev_b32 v102, 16, v244
    v_and_b32 v103, 0xffff0000, v244
    v_lshlrev_b32 v108, 16, v197
    v_and_b32 v109, 0xffff0000, v197
    v_lshlrev_b32 v110, 16, v225
    v_and_b32 v111, 0xffff0000, v225
    v_lshlrev_b32 v114, 16, v245
    v_and_b32 v115, 0xffff0000, v245
    v_cvt_pk_bf16_f32 v124, v122, v123
    v_cvt_pk_bf16_f32 v128, v126, v127
    v_cvt_pk_bf16_f32 v136, v134, v135
    v_cvt_pk_bf16_f32 v140, v138, v139
    v_dot2_f32_bf16 v84, v100, s79, v84
    v_dot2_f32_bf16 v86, v104, s79, v86
    v_dot2_f32_bf16 v85, v112, s79, v85
    v_dot2_f32_bf16 v87, v116, s79, v87
    v_mul_f32 v98, v98, v96
    v_mul_f32 v99, v99, v97
    v_mul_f32 v102, v102, v96
    v_mul_f32 v103, v103, v97
    v_mul_f32 v110, v110, v108
    v_mul_f32 v111, v111, v109
    v_mul_f32 v114, v114, v108
    v_mul_f32 v115, v115, v109
    v_lshlrev_b32 v120, 16, v198
    v_and_b32 v121, 0xffff0000, v198
    v_lshlrev_b32 v122, 16, v226
    v_and_b32 v123, 0xffff0000, v226
    v_lshlrev_b32 v126, 16, v246
    v_and_b32 v127, 0xffff0000, v246
    v_lshlrev_b32 v132, 16, v199
    v_and_b32 v133, 0xffff0000, v199
    v_lshlrev_b32 v134, 16, v227
    v_and_b32 v135, 0xffff0000, v227
    v_lshlrev_b32 v138, 16, v247
    v_and_b32 v139, 0xffff0000, v247
    v_dot2_f32_bf16 v84, v124, s79, v84
    v_dot2_f32_bf16 v86, v128, s79, v86
    v_dot2_f32_bf16 v85, v136, s79, v85
    v_dot2_f32_bf16 v87, v140, s79, v87
    v_cvt_pk_bf16_f32 v100, v98, v99
    v_cvt_pk_bf16_f32 v104, v102, v103
    v_cvt_pk_bf16_f32 v112, v110, v111
    v_cvt_pk_bf16_f32 v116, v114, v115
    v_mul_f32 v122, v122, v120
    v_mul_f32 v123, v123, v121
    v_mul_f32 v126, v126, v120
    v_mul_f32 v127, v127, v121
    v_mul_f32 v134, v134, v132
    v_mul_f32 v135, v135, v133
    v_mul_f32 v138, v138, v132
    v_mul_f32 v139, v139, v133
    v_dot2_f32_bf16 v84, v100, s79, v84
    v_dot2_f32_bf16 v86, v104, s79, v86
    v_dot2_f32_bf16 v85, v112, s79, v85
    v_dot2_f32_bf16 v87, v116, s79, v87
    v_cvt_pk_bf16_f32 v124, v122, v123
    v_cvt_pk_bf16_f32 v128, v126, v127
    v_cvt_pk_bf16_f32 v136, v134, v135
    v_cvt_pk_bf16_f32 v140, v138, v139
    v_dot2_f32_bf16 v84, v124, s79, v84
    v_dot2_f32_bf16 v86, v128, s79, v86
    v_dot2_f32_bf16 v85, v136, s79, v85
    v_dot2_f32_bf16 v87, v140, s79, v87
    s_nop 2
    v_add_f32 v84, v84, v85
    v_add_f32 v86, v86, v87
    s_nop 0
    v_add_f32_dpp v84, v84, v84 row_shr:1 row_mask:0xf bank_mask:0xf
    v_add_f32_dpp v86, v86, v86 row_shr:1 row_mask:0xf bank_mask:0xf
    s_nop 0
    v_add_f32_dpp v84, v84, v84 row_shr:2 row_mask:0xf bank_mask:0xf
    v_add_f32_dpp v86, v86, v86 row_shr:2 row_mask:0xf bank_mask:0xf
    s_nop 0
    v_add_f32_dpp v84, v84, v84 row_shr:4 row_mask:0xf bank_mask:0xf
    v_add_f32_dpp v86, v86, v86 row_shr:4 row_mask:0xf bank_mask:0xf
    s_nop 0
    v_add_f32_dpp v84, v84, v84 row_shr:8 row_mask:0xf bank_mask:0xf
    v_add_f32_dpp v86, v86, v86 row_shr:8 row_mask:0xf bank_mask:0xf
    v_cvt_pk_bf16_f32 v84, v84, v84
    v_cvt_pk_bf16_f32 v86, v86, v86
    v_and_b32 v84, 0xffff0000, v84
    v_and_b32 v86, 0xffff0000, v86
    v_mul_f32 v84, 0xbfb8aa3b, v84
    v_mul_f32 v86, 0xbfb8aa3b, v86
    v_exp_f32 v84, v84
    v_exp_f32 v86, v86
    v_and_b32 v85, 15, v252
    v_add_f32 v84, 1.0, v84
    v_add_f32 v86, 1.0, v86
    v_rcp_f32 v84, v84
    v_rcp_f32 v86, v86
    v_lshlrev_b32 v6, 2, v6
    v_cmp_eq_u32 vcc, 15, v85
    v_cvt_pk_bf16_f32 v84, v84, v84
    v_cvt_pk_bf16_f32 v86, v86, v86
    v_and_b32 v84, 0xffff0000, v84
    v_and_b32 v86, 0xffff0000, v86
    s_nop 1
    v_cndmask_b32 v6, v9, v6, vcc
    buffer_store_dword v84, v6, s[8:11], s30 offen sc1
    buffer_store_dword v86, v6, s[8:11], s30 offen offset:16 sc1
    s_cmp_ge_u32 s24, 2
    s_cbranch_scc1 L_g9
    s_cmp_eq_u32 s24, 0
    s_cbranch_scc0 L_owait
    v_lshlrev_b32 v32, 4, v252
    ds_read_b128 v[96:99], v32 offset:13568
    ds_read_b128 v[112:115], v32 offset:34048
    ds_read_b128 v[100:103], v32 offset:14592
    ds_read_b128 v[116:119], v32 offset:35072
    ds_read_b128 v[104:107], v32 offset:15616
    ds_read_b128 v[120:123], v32 offset:36096
    ds_read_b128 v[108:111], v32 offset:16640
    ds_read_b128 v[124:127], v32 offset:37120
    s_waitcnt lgkmcnt(0)
    v_add_f32 v96, v96, v112
    v_add_f32 v97, v97, v113
    v_add_f32 v98, v98, v114
    v_add_f32 v99, v99, v115
    v_add_f32 v100, v100, v116
    v_add_f32 v101, v101, v117
    v_add_f32 v102, v102, v118
    v_add_f32 v103, v103, v119
    v_add_f32 v104, v104, v120
    v_add_f32 v105, v105, v121
    v_add_f32 v106, v106, v122
    v_add_f32 v107, v107, v123
    v_add_f32 v108, v108, v124
    v_add_f32 v109, v109, v125
    v_add_f32 v110, v110, v126
    v_add_f32 v111, v111, v127
    s_branch L_expand
L_g9:
    s_sub_u32 s79, s24, 2
    s_mul_i32 s33, s79, 1179648
    s_lshl_b32 s78, s25, 1
    s_add_u32 s33, s33, s78
    v_mul_u32_u24 v5, 1152, v252
    buffer_load_ushort v112, v5, s[4:7], s33 offen
    s_add_u32 s33, s33, 73728
    buffer_load_ushort v113, v5, s[4:7], s33 offen
    s_add_u32 s33, s33, 73728
    buffer_load_ushort v114, v5, s[4:7], s33 offen
    s_add_u32 s33, s33, 73728
    buffer_load_ushort v115, v5, s[4:7], s33 offen
    s_add_u32 s33, s33, 73728
    buffer_load_ushort v116, v5, s[4:7], s33 offen
    s_add_u32 s33, s33, 73728
    buffer_load_ushort v117, v5, s[4:7], s33 offen
    s_add_u32 s33, s33, 73728
    buffer_load_ushort v118, v5, s[4:7], s33 offen
    s_add_u32 s33, s33, 73728
    buffer_load_ushort v119, v5, s[4:7], s33 offen
    s_add_u32 s33, s33, 73728
    buffer_load_ushort v120, v5, s[4:7], s33 offen
    s_add_u32 s33, s33, 73728
    buffer_load_ushort v121, v5, s[4:7], s33 offen
    s_add_u32 s33, s33, 73728
    buffer_load_ushort v122, v5, s[4:7], s33 offen
    s_add_u32 s33, s33, 73728
    buffer_load_ushort v123, v5, s[4:7], s33 offen
    s_add_u32 s33, s33, 73728
    buffer_load_ushort v124, v5, s[4:7], s33 offen
    s_add_u32 s33, s33, 73728
    buffer_load_ushort v125, v5, s[4:7], s33 offen
    s_add_u32 s33, s33, 73728
    buffer_load_ushort v126, v5, s[4:7], s33 offen
    s_add_u32 s33, s33, 73728
    buffer_load_ushort v127, v5, s[4:7], s33 offen
    v_lshlrev_b32 v80, 6, v3
    v_xor_b32 v81, 7, v2
    v_lshl_add_u32 v80, v81, 1, v80
    s_lshl_b32 s79, s79, 11
    s_add_u32 s79, s79, 54784
    v_add_u32 v80, s79, v80
    v_xor_b32 v78, 32, v80
    v_lshlrev_b32 v82, 2, v252
    v_add_u32 v82, 54720, v82
    v_mov_b32 v83, 0
    v_cmp_gt_u32 vcc, 16, v252
    s_and_saveexec_b64 s[80:81], vcc
    ds_write_b32 v82, v83
    s_mov_b64 exec, s[80:81]
    s_waitcnt vmcnt(12) lgkmcnt(4)
    ds_write_b16 v80, v112 offset:0
    ds_write_b16 v80, v113 offset:128
    ds_write_b16 v78, v114 offset:256
    ds_write_b16 v78, v115 offset:384
    s_waitcnt vmcnt(8) lgkmcnt(4)
    ds_write_b16 v80, v116 offset:512
    ds_write_b16 v80, v117 offset:640
    ds_write_b16 v78, v118 offset:768
    ds_write_b16 v78, v119 offset:896
    s_waitcnt vmcnt(4) lgkmcnt(4)
    ds_write_b16 v80, v120 offset:1024
    ds_write_b16 v80, v121 offset:1152
    ds_write_b16 v78, v122 offset:1280
    ds_write_b16 v78, v123 offset:1408
    s_waitcnt vmcnt(0) lgkmcnt(4)
    ds_write_b16 v80, v124 offset:1536
    ds_write_b16 v80, v125 offset:1664
    ds_write_b16 v78, v126 offset:1792
    ds_write_b16 v78, v127 offset:1920
L_osig:
    v_mov_b32 v32, 0
    v_mov_b32 v33, 1
    s_waitcnt lgkmcnt(0)
    s_mov_b64 s[80:81], exec
    s_mov_b64 exec, 1
    ds_add_u32 v32, v33 offset:40944
    s_mov_b64 exec, s[80:81]
L_owait:
    v_mov_b32 v32, 0
    s_mov_b32 s101, 0
L_ow:
    ds_read_b32 v33, v32 offset:40944
    s_add_u32 s101, s101, 1
    s_waitcnt lgkmcnt(0)
    v_readfirstlane_b32 s78, v33
    s_cmp_ge_u32 s101, 50000
    s_cbranch_scc1 L_ow1
    s_cmp_ge_u32 s78, 3
    s_cbranch_scc1 L_ow1
    s_sleep 2
    s_branch L_ow
L_ow1:
    s_mov_b32 s35, 0
    s_mov_b32 s36, 54272
    s_lshl_b32 s37, s24, 2
    s_mov_b32 s78, 6
    s_branch L_convset
L_coopred:
    s_add_u32 s78, s28, 5200
    s_add_u32 s79, s78, 4096
    s_cmp_eq_u32 s24, 0
    s_cselect_b32 s78, 34048, s78
    s_cselect_b32 s79, 75008, s79
    v_lshl_add_u32 v32, v252, 4, s78
    v_lshl_add_u32 v33, v252, 4, s79
    s_waitcnt lgkmcnt(0)
    ds_write_b128 v32, v[44:47] offset:0
    ds_write_b128 v32, v[48:51] offset:1024
    ds_write_b128 v32, v[52:55] offset:2048
    ds_write_b128 v32, v[56:59] offset:3072
    ds_write_b128 v33, v[60:63] offset:0
    ds_write_b128 v33, v[64:67] offset:1024
    ds_write_b128 v33, v[68:71] offset:2048
    ds_write_b128 v33, v[72:75] offset:3072
L_coop:
    v_bfe_u32 v36, v252, 2, 2
    v_mul_u32_u24 v36, 20544, v36
    s_lshl_b32 s78, s24, 3
    v_add_u32 v37, s78, v3
    v_mul_u32_u24 v37, 72, v37
    v_add_u32 v36, v36, v37
    v_bfe_u32 v37, v252, 4, 1
    v_lshl_add_u32 v36, v37, 5, v36
    v_and_b32 v37, 3, v252
    v_lshl_add_u32 v36, v37, 3, v36
    v_add_u32 v37, 81920, v36
    s_add_u32 s78, s25, 8
    s_lshl_b32 s78, s78, 11
    s_lshl_b32 s79, s24, 8
    s_add_u32 s78, s78, s79
    v_add_u32 v38, s78, v252
    v_lshlrev_b32 v38, 4, v38
    v_lshlrev_b32 v19, 16, v207
    s_waitcnt lgkmcnt(0)
    s_barrier
    ds_read_b64_tr_b16 v[180:181], v36 offset:0
    ds_read_b64_tr_b16 v[182:183], v37 offset:0
    ds_read_b64_tr_b16 v[184:185], v36 offset:144
    ds_read_b64_tr_b16 v[186:187], v37 offset:144
    ds_read_b64_tr_b16 v[188:189], v36 offset:288
    ds_read_b64_tr_b16 v[190:191], v37 offset:288
    ds_read_b64_tr_b16 v[192:193], v36 offset:432
    ds_read_b64_tr_b16 v[194:195], v37 offset:432
    s_waitcnt lgkmcnt(6)
    buffer_store_dwordx4 v[180:183], v38, s[8:11], s29 offen offset:0 sc1
    s_waitcnt lgkmcnt(4)
    buffer_store_dwordx4 v[184:187], v38, s[8:11], s29 offen offset:1024 sc1
    s_waitcnt lgkmcnt(2)
    buffer_store_dwordx4 v[188:191], v38, s[8:11], s29 offen offset:2048 sc1
    s_waitcnt lgkmcnt(0)
    buffer_store_dwordx4 v[192:195], v38, s[8:11], s29 offen offset:3072 sc1
    s_and_b32 s74, s24, 3
    s_lshr_b32 s75, s24, 2
    s_lshl_b32 s76, s24, 10
    s_add_u32 s76, s76, 25680
    v_lshl_add_u32 v34, v252, 4, s76
    v_add_u32 v35, 61440, v34
    s_mul_i32 s76, s75, 40960
    s_lshl_b32 s77, s74, 10
    s_add_u32 s76, s76, s77
    s_add_u32 s76, s76, 34048
    v_lshl_add_u32 v36, v252, 4, s76
    v_lshrrev_b32 v37, 1, v41
    v_lshlrev_b32 v37, 4, v37
    v_and_b32 v38, 1, v41
    v_lshlrev_b32 v38, 3, v38
    v_sub_u32 v37, v37, v38
    v_add_u32 v37, v37, v42
    v_bfe_u32 v38, v40, 2, 1
    v_xor_b32 v38, s75, v38
    v_lshl_add_u32 v37, v38, 5, v37
    s_lshl_b32 s76, s74, 10
    s_lshl_b32 s77, s75, 5
    s_add_u32 s76, s76, 54792
    v_add_u32 v37, s76, v37
    s_lshl_b32 s76, s74, 10
    s_add_u32 s76, s76, s77
    v_lshlrev_b32 v38, 6, v40
    v_lshl_add_u32 v38, v41, 3, v38
    v_add_u32 v38, s76, v38
    s_lshl_b32 s78, s24, 9
    v_lshl_add_u32 v47, v252, 3, s78
    s_lshl_b32 s78, s25, 12
    s_add_u32 s78, s78, s32
    ds_read_b64 v[48:49], v37
    ds_read_b128 v[80:83], v36
    ds_read_b128 v[84:87], v34 offset:0
    ds_read_b128 v[88:91], v34 offset:20480
    ds_read_b128 v[92:95], v34 offset:40960
    s_waitcnt lgkmcnt(4)
    v_and_b32 v50, 0xffff0000, v49
    v_lshlrev_b32 v51, 16, v49
    v_and_b32 v52, 0xffff0000, v48
    v_lshlrev_b32 v53, 16, v48
    s_waitcnt lgkmcnt(3)
    v_fmac_f32 v80, v19, v50
    v_fmac_f32 v81, v19, v51
    v_fmac_f32 v82, v19, v52
    v_fmac_f32 v83, v19, v53
    s_waitcnt lgkmcnt(2)
    v_add_f32 v80, v80, v84
    v_add_f32 v81, v81, v85
    v_add_f32 v82, v82, v86
    v_add_f32 v83, v83, v87
    s_waitcnt lgkmcnt(1)
    v_add_f32 v80, v80, v88
    v_add_f32 v81, v81, v89
    v_add_f32 v82, v82, v90
    v_add_f32 v83, v83, v91
    s_waitcnt lgkmcnt(0)
    v_add_f32 v80, v80, v92
    v_add_f32 v81, v81, v93
    v_add_f32 v82, v82, v94
    v_add_f32 v83, v83, v95
    v_cvt_pk_bf16_f32 v48, v80, v81
    v_cvt_pk_bf16_f32 v49, v82, v83
    v_add_u32 v38, 87120, v38
    v_add_u32 v46, 87120, v47
    ds_write_b64 v38, v[48:49]
    s_waitcnt lgkmcnt(0)
    s_barrier
    ds_read_b64 v[48:49], v46
    v_mov_b32 v50, 0
    s_waitcnt lgkmcnt(0)
    buffer_store_dwordx2 v[48:49], v47, s[8:11], s78 offen sc1
    s_mov_b32 s101, 0
L_sclr:
    global_load_dword v51, v50, s[54:55] sc1
    s_add_u32 s101, s101, 1
    s_waitcnt vmcnt(0)
    v_readfirstlane_b32 s78, v51
    s_cmp_ge_u32 s101, 50000
    s_cbranch_scc1 L_sclr1
    s_cmp_lg_u32 s78, 0
    s_cbranch_scc0 L_sclr
L_sclr1:
    s_barrier
    s_lshr_b32 s78, s25, 3
    s_lshl_b32 s78, s78, 7
    s_and_b32 s79, s25, 7
    s_lshl_b32 s79, s79, 2
    s_add_u32 s78, s78, s79
    s_add_u32 s78, s78, 2048
    s_cmp_eq_u32 s24, 0
    s_cselect_b32 s78, s78, 2146435072
    v_mov_b32 v48, s78
    v_cmp_eq_u32 vcc, 0, v252
    v_mov_b32 v49, 1
    s_nop 0
    v_cndmask_b32 v48, v9, v48, vcc
    buffer_store_dword v49, v48, s[8:11], s31 offen sc1
    s_and_b32 s78, s2, 1
    s_xor_b32 s78, s78, 1
    s_lshl_b32 s78, s78, 5
    s_bfe_u32 s79, s2, 0x20001
    s_lshl_b32 s79, s79, 3
    s_add_u32 s78, s78, s79
    s_add_u32 s27, s78, s39
    v_lshrrev_b32 v20, 3, v252
    v_and_b32 v21, 7, v252
    v_lshlrev_b32 v20, 7, v20
    v_lshl_add_u32 v20, v21, 2, v20
    v_add_u32 v20, 2048, v20
    s_lshr_b32 s78, s27, 2
    s_lshl_b32 s78, s78, 7
    v_lshl_add_u32 v22, v252, 2, s78
    v_cmp_gt_u32 s[74:75], 12, v252
    s_and_b32 s76, s24, 3
    s_lshr_b32 s77, s24, 2
    v_cndmask_b32 v22, v9, v22, s[74:75]
    s_lshl_b32 s78, s27, 5
    v_add_u32 v23, s78, v2
    s_lshl_b32 s79, s24, 1
    v_add_u32 v24, s79, v3
    v_lshl_add_u32 v25, v24, 11, v23
    v_lshlrev_b32 v25, 4, v25
    v_mul_u32_u24 v26, 1152, v23
    v_lshl_add_u32 v26, v24, 4, v26
    v_lshlrev_b32 v27, 2, v23
    v_lshlrev_b32 v28, 4, v252
    s_lshl_b32 s33, s27, 2
    s_add_u32 s33, s33, s76
    s_lshl_b32 s33, s33, 10
    s_mul_i32 s34, s77, 3145728
    s_add_u32 s33, s33, s34
    s_cmp_eq_u32 s24, 7
    s_cbranch_scc0 L_sp0_ok
    v_mov_b32 v31, 2
    v_cndmask_b32 v31, v50, v31, s[74:75]
    s_mov_b32 s101, 0
L_sp0:
    buffer_load_dword v29, v22, s[8:11], s31 offen sc1
    s_waitcnt vmcnt(0)
    v_cmp_lt_u32 vcc, v29, v31
    s_add_u32 s101, s101, 1
    s_cmp_lt_u32 s101, 50000
    s_cbranch_vccz L_sp0_ok
    s_sleep 8
    s_cbranch_scc1 L_sp0
L_sp0_ok:
    s_barrier
    s_mov_b32 s35, s33
    buffer_load_dwordx4 v[64:67], v28, s[8:11], s35 offen sc1
    s_add_u32 s35, s35, 262144
    buffer_load_dwordx4 v[68:71], v28, s[8:11], s35 offen sc1
    s_add_u32 s35, s35, 262144
    buffer_load_dwordx4 v[72:75], v28, s[8:11], s35 offen sc1
    s_add_u32 s35, s35, 262144
    buffer_load_dwordx4 v[76:79], v28, s[8:11], s35 offen sc1
    s_add_u32 s35, s35, 262144
    buffer_load_dwordx4 v[80:83], v28, s[8:11], s35 offen sc1
    s_add_u32 s35, s35, 262144
    buffer_load_dwordx4 v[84:87], v28, s[8:11], s35 offen sc1
    s_add_u32 s35, s35, 262144
    buffer_load_dwordx4 v[88:91], v28, s[8:11], s35 offen sc1
    s_add_u32 s35, s35, 262144
    buffer_load_dwordx4 v[92:95], v28, s[8:11], s35 offen sc1
    s_add_u32 s35, s35, 262144
    buffer_load_dwordx4 v[96:99], v28, s[8:11], s35 offen sc1
    s_add_u32 s35, s35, 262144
    buffer_load_dwordx4 v[100:103], v28, s[8:11], s35 offen sc1
    s_add_u32 s35, s35, 262144
    buffer_load_dwordx4 v[104:107], v28, s[8:11], s35 offen sc1
    s_add_u32 s35, s35, 262144
    buffer_load_dwordx4 v[108:111], v28, s[8:11], s35 offen sc1
    s_cmp_eq_u32 s24, 7
    s_cbranch_scc0 L_sp2_ok
    v_mov_b32 v31, 4
    v_cndmask_b32 v31, v50, v31, s[74:75]
    s_mov_b32 s101, 0
L_sp2:
    buffer_load_dword v29, v22, s[8:11], s31 offen sc1
    s_waitcnt vmcnt(0)
    v_cmp_lt_u32 vcc, v29, v31
    s_add_u32 s101, s101, 1
    s_cmp_lt_u32 s101, 50000
    s_cbranch_vccz L_sp2_ok
    s_sleep 8
    s_cbranch_scc1 L_sp2
L_sp2_ok:
    s_barrier
    s_add_u32 s33, s33, 6291456
    s_mov_b32 s35, s33
    buffer_load_dwordx4 v[112:115], v28, s[8:11], s35 offen sc1
    s_add_u32 s35, s35, 262144
    buffer_load_dwordx4 v[116:119], v28, s[8:11], s35 offen sc1
    s_add_u32 s35, s35, 262144
    buffer_load_dwordx4 v[120:123], v28, s[8:11], s35 offen sc1
    s_add_u32 s35, s35, 262144
    buffer_load_dwordx4 v[124:127], v28, s[8:11], s35 offen sc1
    s_add_u32 s35, s35, 262144
    buffer_load_dwordx4 v[128:131], v28, s[8:11], s35 offen sc1
    s_add_u32 s35, s35, 262144
    buffer_load_dwordx4 v[132:135], v28, s[8:11], s35 offen sc1
    s_add_u32 s35, s35, 262144
    buffer_load_dwordx4 v[136:139], v28, s[8:11], s35 offen sc1
    s_add_u32 s35, s35, 262144
    buffer_load_dwordx4 v[140:143], v28, s[8:11], s35 offen sc1
    s_add_u32 s35, s35, 262144
    buffer_load_dwordx4 v[144:147], v28, s[8:11], s35 offen sc1
    s_add_u32 s35, s35, 262144
    buffer_load_dwordx4 v[148:151], v28, s[8:11], s35 offen sc1
    s_add_u32 s35, s35, 262144
    buffer_load_dwordx4 v[152:155], v28, s[8:11], s35 offen sc1
    s_add_u32 s35, s35, 262144
    buffer_load_dwordx4 v[156:159], v28, s[8:11], s35 offen sc1
L_e1:
    s_cmp_eq_u32 s24, 7
    s_cbranch_scc0 L_sp1_ok
    s_mov_b32 s101, 0
L_sp1:
    buffer_load_dword v29, v20, s[8:11], s31 offen sc1
    s_waitcnt vmcnt(0)
    v_cmp_lt_u32 vcc, v29, v49
    s_add_u32 s101, s101, 1
    s_cmp_lt_u32 s101, 50000
    s_cbranch_vccz L_sp1_ok
    s_sleep 8
    s_cbranch_scc1 L_sp1
L_sp1_ok:
    s_barrier
    buffer_load_dword v30, v27, s[8:11], s30 offen sc1
    v_add_u32 v31, 524288, v25
    buffer_load_dwordx4 v[16:19], v31, s[8:11], s29 offen sc1
    s_cmp_ge_u32 s24, 4
    s_cbranch_scc1 L_eiter
    v_lshrrev_b32 v31, 2, v252
    s_lshl_b32 s78, s76, 4
    v_add_u32 v31, s78, v31
    v_lshlrev_b32 v31, 12, v31
    v_and_b32 v32, 3, v252
    v_lshl_add_u32 v31, v32, 4, v31
    s_lshl_b32 s78, s27, 6
    s_add_u32 s78, s78, s32
    buffer_load_dwordx4 v[12:15], v31, s[8:11], s78 offen sc1
    v_add_u32 v33, s28, v28
    v_bfe_u32 v34, v252, 2, 2
    v_lshl_add_u32 v34, v3, 3, v34
    v_lshlrev_b32 v34, 6, v34
    v_bfe_u32 v35, v252, 4, 1
    v_lshl_add_u32 v34, v35, 5, v34
    v_lshl_add_u32 v34, v32, 3, v34
    v_add_u32 v34, s28, v34
    s_branch L_esum
L_eiter:
    buffer_load_dwordx4 v[12:15], v25, s[8:11], s29 offen sc1
L_esum:
    s_mov_b32 s36, 0x3f80
    s_mov_b32 s37, 0x3f800000
    s_waitcnt vmcnt(25)
    v_lshlrev_b32 v208, 16, v64
    v_and_b32 v209, 0xffff0000, v64
    v_lshlrev_b32 v210, 16, v65
    v_and_b32 v211, 0xffff0000, v65
    v_lshlrev_b32 v212, 16, v66
    v_and_b32 v213, 0xffff0000, v66
    v_lshlrev_b32 v214, 16, v67
    v_and_b32 v215, 0xffff0000, v67
    v_dot2_f32_bf16 v208, v68, s36, v208
    v_dot2_f32_bf16 v209, v68, s37, v209
    v_dot2_f32_bf16 v210, v69, s36, v210
    v_dot2_f32_bf16 v211, v69, s37, v211
    v_dot2_f32_bf16 v212, v70, s36, v212
    v_dot2_f32_bf16 v213, v70, s37, v213
    v_dot2_f32_bf16 v214, v71, s36, v214
    v_dot2_f32_bf16 v215, v71, s37, v215
    s_waitcnt vmcnt(23)
    v_dot2_f32_bf16 v208, v72, s36, v208
    v_dot2_f32_bf16 v209, v72, s37, v209
    v_dot2_f32_bf16 v210, v73, s36, v210
    v_dot2_f32_bf16 v211, v73, s37, v211
    v_dot2_f32_bf16 v212, v74, s36, v212
    v_dot2_f32_bf16 v213, v74, s37, v213
    v_dot2_f32_bf16 v214, v75, s36, v214
    v_dot2_f32_bf16 v215, v75, s37, v215
    v_dot2_f32_bf16 v208, v76, s36, v208
    v_dot2_f32_bf16 v209, v76, s37, v209
    v_dot2_f32_bf16 v210, v77, s36, v210
    v_dot2_f32_bf16 v211, v77, s37, v211
    v_dot2_f32_bf16 v212, v78, s36, v212
    v_dot2_f32_bf16 v213, v78, s37, v213
    v_dot2_f32_bf16 v214, v79, s36, v214
    v_dot2_f32_bf16 v215, v79, s37, v215
    s_waitcnt vmcnt(21)
    v_dot2_f32_bf16 v208, v80, s36, v208
    v_dot2_f32_bf16 v209, v80, s37, v209
    v_dot2_f32_bf16 v210, v81, s36, v210
    v_dot2_f32_bf16 v211, v81, s37, v211
    v_dot2_f32_bf16 v212, v82, s36, v212
    v_dot2_f32_bf16 v213, v82, s37, v213
    v_dot2_f32_bf16 v214, v83, s36, v214
    v_dot2_f32_bf16 v215, v83, s37, v215
    v_dot2_f32_bf16 v208, v84, s36, v208
    v_dot2_f32_bf16 v209, v84, s37, v209
    v_dot2_f32_bf16 v210, v85, s36, v210
    v_dot2_f32_bf16 v211, v85, s37, v211
    v_dot2_f32_bf16 v212, v86, s36, v212
    v_dot2_f32_bf16 v213, v86, s37, v213
    v_dot2_f32_bf16 v214, v87, s36, v214
    v_dot2_f32_bf16 v215, v87, s37, v215
    s_waitcnt vmcnt(19)
    v_dot2_f32_bf16 v208, v88, s36, v208
    v_dot2_f32_bf16 v209, v88, s37, v209
    v_dot2_f32_bf16 v210, v89, s36, v210
    v_dot2_f32_bf16 v211, v89, s37, v211
    v_dot2_f32_bf16 v212, v90, s36, v212
    v_dot2_f32_bf16 v213, v90, s37, v213
    v_dot2_f32_bf16 v214, v91, s36, v214
    v_dot2_f32_bf16 v215, v91, s37, v215
    v_dot2_f32_bf16 v208, v92, s36, v208
    v_dot2_f32_bf16 v209, v92, s37, v209
    v_dot2_f32_bf16 v210, v93, s36, v210
    v_dot2_f32_bf16 v211, v93, s37, v211
    v_dot2_f32_bf16 v212, v94, s36, v212
    v_dot2_f32_bf16 v213, v94, s37, v213
    v_dot2_f32_bf16 v214, v95, s36, v214
    v_dot2_f32_bf16 v215, v95, s37, v215
    s_waitcnt vmcnt(17)
    v_dot2_f32_bf16 v208, v96, s36, v208
    v_dot2_f32_bf16 v209, v96, s37, v209
    v_dot2_f32_bf16 v210, v97, s36, v210
    v_dot2_f32_bf16 v211, v97, s37, v211
    v_dot2_f32_bf16 v212, v98, s36, v212
    v_dot2_f32_bf16 v213, v98, s37, v213
    v_dot2_f32_bf16 v214, v99, s36, v214
    v_dot2_f32_bf16 v215, v99, s37, v215
    v_dot2_f32_bf16 v208, v100, s36, v208
    v_dot2_f32_bf16 v209, v100, s37, v209
    v_dot2_f32_bf16 v210, v101, s36, v210
    v_dot2_f32_bf16 v211, v101, s37, v211
    v_dot2_f32_bf16 v212, v102, s36, v212
    v_dot2_f32_bf16 v213, v102, s37, v213
    v_dot2_f32_bf16 v214, v103, s36, v214
    v_dot2_f32_bf16 v215, v103, s37, v215
    s_waitcnt vmcnt(15)
    v_dot2_f32_bf16 v208, v104, s36, v208
    v_dot2_f32_bf16 v209, v104, s37, v209
    v_dot2_f32_bf16 v210, v105, s36, v210
    v_dot2_f32_bf16 v211, v105, s37, v211
    v_dot2_f32_bf16 v212, v106, s36, v212
    v_dot2_f32_bf16 v213, v106, s37, v213
    v_dot2_f32_bf16 v214, v107, s36, v214
    v_dot2_f32_bf16 v215, v107, s37, v215
    v_dot2_f32_bf16 v208, v108, s36, v208
    v_dot2_f32_bf16 v209, v108, s37, v209
    v_dot2_f32_bf16 v210, v109, s36, v210
    v_dot2_f32_bf16 v211, v109, s37, v211
    v_dot2_f32_bf16 v212, v110, s36, v212
    v_dot2_f32_bf16 v213, v110, s37, v213
    v_dot2_f32_bf16 v214, v111, s36, v214
    v_dot2_f32_bf16 v215, v111, s37, v215
    s_mov_b32 s36, 0x3f80
    s_mov_b32 s37, 0x3f800000
    s_waitcnt vmcnt(13)
    v_lshlrev_b32 v216, 16, v112
    v_and_b32 v217, 0xffff0000, v112
    v_lshlrev_b32 v218, 16, v113
    v_and_b32 v219, 0xffff0000, v113
    v_lshlrev_b32 v220, 16, v114
    v_and_b32 v221, 0xffff0000, v114
    v_lshlrev_b32 v222, 16, v115
    v_and_b32 v223, 0xffff0000, v115
    v_dot2_f32_bf16 v216, v116, s36, v216
    v_dot2_f32_bf16 v217, v116, s37, v217
    v_dot2_f32_bf16 v218, v117, s36, v218
    v_dot2_f32_bf16 v219, v117, s37, v219
    v_dot2_f32_bf16 v220, v118, s36, v220
    v_dot2_f32_bf16 v221, v118, s37, v221
    v_dot2_f32_bf16 v222, v119, s36, v222
    v_dot2_f32_bf16 v223, v119, s37, v223
    s_waitcnt vmcnt(11)
    v_dot2_f32_bf16 v216, v120, s36, v216
    v_dot2_f32_bf16 v217, v120, s37, v217
    v_dot2_f32_bf16 v218, v121, s36, v218
    v_dot2_f32_bf16 v219, v121, s37, v219
    v_dot2_f32_bf16 v220, v122, s36, v220
    v_dot2_f32_bf16 v221, v122, s37, v221
    v_dot2_f32_bf16 v222, v123, s36, v222
    v_dot2_f32_bf16 v223, v123, s37, v223
    v_dot2_f32_bf16 v216, v124, s36, v216
    v_dot2_f32_bf16 v217, v124, s37, v217
    v_dot2_f32_bf16 v218, v125, s36, v218
    v_dot2_f32_bf16 v219, v125, s37, v219
    v_dot2_f32_bf16 v220, v126, s36, v220
    v_dot2_f32_bf16 v221, v126, s37, v221
    v_dot2_f32_bf16 v222, v127, s36, v222
    v_dot2_f32_bf16 v223, v127, s37, v223
    s_waitcnt vmcnt(9)
    v_dot2_f32_bf16 v216, v128, s36, v216
    v_dot2_f32_bf16 v217, v128, s37, v217
    v_dot2_f32_bf16 v218, v129, s36, v218
    v_dot2_f32_bf16 v219, v129, s37, v219
    v_dot2_f32_bf16 v220, v130, s36, v220
    v_dot2_f32_bf16 v221, v130, s37, v221
    v_dot2_f32_bf16 v222, v131, s36, v222
    v_dot2_f32_bf16 v223, v131, s37, v223
    v_dot2_f32_bf16 v216, v132, s36, v216
    v_dot2_f32_bf16 v217, v132, s37, v217
    v_dot2_f32_bf16 v218, v133, s36, v218
    v_dot2_f32_bf16 v219, v133, s37, v219
    v_dot2_f32_bf16 v220, v134, s36, v220
    v_dot2_f32_bf16 v221, v134, s37, v221
    v_dot2_f32_bf16 v222, v135, s36, v222
    v_dot2_f32_bf16 v223, v135, s37, v223
    s_waitcnt vmcnt(7)
    v_dot2_f32_bf16 v216, v136, s36, v216
    v_dot2_f32_bf16 v217, v136, s37, v217
    v_dot2_f32_bf16 v218, v137, s36, v218
    v_dot2_f32_bf16 v219, v137, s37, v219
    v_dot2_f32_bf16 v220, v138, s36, v220
    v_dot2_f32_bf16 v221, v138, s37, v221
    v_dot2_f32_bf16 v222, v139, s36, v222
    v_dot2_f32_bf16 v223, v139, s37, v223
    v_dot2_f32_bf16 v216, v140, s36, v216
    v_dot2_f32_bf16 v217, v140, s37, v217
    v_dot2_f32_bf16 v218, v141, s36, v218
    v_dot2_f32_bf16 v219, v141, s37, v219
    v_dot2_f32_bf16 v220, v142, s36, v220
    v_dot2_f32_bf16 v221, v142, s37, v221
    v_dot2_f32_bf16 v222, v143, s36, v222
    v_dot2_f32_bf16 v223, v143, s37, v223
    s_waitcnt vmcnt(5)
    v_dot2_f32_bf16 v216, v144, s36, v216
    v_dot2_f32_bf16 v217, v144, s37, v217
    v_dot2_f32_bf16 v218, v145, s36, v218
    v_dot2_f32_bf16 v219, v145, s37, v219
    v_dot2_f32_bf16 v220, v146, s36, v220
    v_dot2_f32_bf16 v221, v146, s37, v221
    v_dot2_f32_bf16 v222, v147, s36, v222
    v_dot2_f32_bf16 v223, v147, s37, v223
    v_dot2_f32_bf16 v216, v148, s36, v216
    v_dot2_f32_bf16 v217, v148, s37, v217
    v_dot2_f32_bf16 v218, v149, s36, v218
    v_dot2_f32_bf16 v219, v149, s37, v219
    v_dot2_f32_bf16 v220, v150, s36, v220
    v_dot2_f32_bf16 v221, v150, s37, v221
    v_dot2_f32_bf16 v222, v151, s36, v222
    v_dot2_f32_bf16 v223, v151, s37, v223
    s_waitcnt vmcnt(3)
    v_dot2_f32_bf16 v216, v152, s36, v216
    v_dot2_f32_bf16 v217, v152, s37, v217
    v_dot2_f32_bf16 v218, v153, s36, v218
    v_dot2_f32_bf16 v219, v153, s37, v219
    v_dot2_f32_bf16 v220, v154, s36, v220
    v_dot2_f32_bf16 v221, v154, s37, v221
    v_dot2_f32_bf16 v222, v155, s36, v222
    v_dot2_f32_bf16 v223, v155, s37, v223
    v_dot2_f32_bf16 v216, v156, s36, v216
    v_dot2_f32_bf16 v217, v156, s37, v217
    v_dot2_f32_bf16 v218, v157, s36, v218
    v_dot2_f32_bf16 v219, v157, s37, v219
    v_dot2_f32_bf16 v220, v158, s36, v220
    v_dot2_f32_bf16 v221, v158, s37, v221
    v_dot2_f32_bf16 v222, v159, s36, v222
    v_dot2_f32_bf16 v223, v159, s37, v223
    s_waitcnt vmcnt(0)
    s_cmp_ge_u32 s24, 4
    s_cbranch_scc1 L_emix
    ds_write_b128 v33, v[12:15]
    s_waitcnt lgkmcnt(0)
    ds_read_b64_tr_b16 v[12:13], v34
    ds_read_b64_tr_b16 v[14:15], v34 offset:256
    s_waitcnt lgkmcnt(0)
L_emix:
    v_sub_f32 v32, 1.0, v30
    v_cvt_pk_bf16_f32 v32, v32, v32
    v_and_b32 v32, 0xffff0000, v32
    v_permlane16_swap_b32 v208, v212
    v_permlane16_swap_b32 v209, v213
    v_permlane16_swap_b32 v210, v214
    v_permlane16_swap_b32 v211, v215
    v_lshlrev_b32 v64, 16, v12
    v_and_b32 v65, 0xffff0000, v12
    v_lshlrev_b32 v66, 16, v13
    v_and_b32 v67, 0xffff0000, v13
    v_lshlrev_b32 v68, 16, v14
    v_and_b32 v69, 0xffff0000, v14
    v_lshlrev_b32 v70, 16, v15
    v_and_b32 v71, 0xffff0000, v15
    v_mul_f32 v64, v30, v64
    v_mul_f32 v65, v30, v65
    v_mul_f32 v66, v30, v66
    v_mul_f32 v67, v30, v67
    v_mul_f32 v68, v30, v68
    v_mul_f32 v69, v30, v69
    v_mul_f32 v70, v30, v70
    v_mul_f32 v71, v30, v71
    v_fmac_f32 v64, v32, v208
    v_fmac_f32 v65, v32, v209
    v_fmac_f32 v66, v32, v210
    v_fmac_f32 v67, v32, v211
    v_fmac_f32 v68, v32, v212
    v_fmac_f32 v69, v32, v213
    v_fmac_f32 v70, v32, v214
    v_fmac_f32 v71, v32, v215
    v_cvt_pk_bf16_f32 v72, v64, v65
    v_cvt_pk_bf16_f32 v73, v66, v67
    v_cvt_pk_bf16_f32 v74, v68, v69
    v_cvt_pk_bf16_f32 v75, v70, v71
    buffer_store_dwordx4 v[72:75], v26, s[12:15], 0 offen offset:0
    v_sub_f32 v32, 1.0, v30
    v_cvt_pk_bf16_f32 v32, v32, v32
    v_and_b32 v32, 0xffff0000, v32
    v_permlane16_swap_b32 v216, v220
    v_permlane16_swap_b32 v217, v221
    v_permlane16_swap_b32 v218, v222
    v_permlane16_swap_b32 v219, v223
    v_lshlrev_b32 v112, 16, v16
    v_and_b32 v113, 0xffff0000, v16
    v_lshlrev_b32 v114, 16, v17
    v_and_b32 v115, 0xffff0000, v17
    v_lshlrev_b32 v116, 16, v18
    v_and_b32 v117, 0xffff0000, v18
    v_lshlrev_b32 v118, 16, v19
    v_and_b32 v119, 0xffff0000, v19
    v_mul_f32 v112, v30, v112
    v_mul_f32 v113, v30, v113
    v_mul_f32 v114, v30, v114
    v_mul_f32 v115, v30, v115
    v_mul_f32 v116, v30, v116
    v_mul_f32 v117, v30, v117
    v_mul_f32 v118, v30, v118
    v_mul_f32 v119, v30, v119
    v_fmac_f32 v112, v32, v216
    v_fmac_f32 v113, v32, v217
    v_fmac_f32 v114, v32, v218
    v_fmac_f32 v115, v32, v219
    v_fmac_f32 v116, v32, v220
    v_fmac_f32 v117, v32, v221
    v_fmac_f32 v118, v32, v222
    v_fmac_f32 v119, v32, v223
    v_cvt_pk_bf16_f32 v120, v112, v113
    v_cvt_pk_bf16_f32 v121, v114, v115
    v_cvt_pk_bf16_f32 v122, v116, v117
    v_cvt_pk_bf16_f32 v123, v118, v119
    buffer_store_dwordx4 v[120:123], v26, s[12:15], 0 offen offset:256
    s_endpgm
L_mainexit:
    s_endpgm
.section .rodata,"a"
.p2align 6
.amdhsa_kernel gated_mix__ssm_conv_s4__dense_activation_mish__prompt_kernel
  .amdhsa_next_free_vgpr 256
  .amdhsa_next_free_sgpr 102
  .amdhsa_accum_offset 256
  .amdhsa_group_segment_fixed_size 0
  .amdhsa_kernarg_size 136
  .amdhsa_user_sgpr_count 2
  .amdhsa_user_sgpr_kernarg_segment_ptr 1
  .amdhsa_system_sgpr_workgroup_id_x 1
.end_amdhsa_kernel
```
